```python
import torch

def _softmax(x, axis=-1):
    return torch.softmax(x, dim=axis)
def _gelu(x):
    return torch.nn.functional.gelu(x, approximate="tanh")
def _silu(x):
    return torch.nn.functional.silu(x)
def _sigmoid(x):
    return torch.sigmoid(x)
def _layernorm(x, axis=-1, eps=1e-5):
    m = x.mean(dim=axis, keepdim=True)
    v = x.var(dim=axis, keepdim=True, unbiased=False)
    return (x - m) / torch.sqrt(v + eps)
def _scatter_add(tgt, idx, src, axis=0):
    return tgt.clone().index_add_(axis, idx, src)
def _segment_sum(src, seg, n):
    out = torch.zeros((n,) + src.shape[1:], dtype=src.dtype)
    return out.index_add_(0, seg, src)
def _pad(x, pw):
    flat = tuple(v for pair in reversed(pw) for v in pair)
    return torch.nn.functional.pad(x, flat)

kernel_name = 'interleave_layers__gqa_block_cached__mixer_channel_mlp__decode'

def setup_inputs():

    _w = (lambda a: (lambda t: t.to(torch.bfloat16) if t.is_floating_point() else t)(torch.as_tensor(a)))
    def _A_setup():
        B, Sq, D = 1, 1, 640
        Hq, Hkv, Sk, Dh = 32, 32, 4096, 128
        assert Hq % Hkv == 0, (Hq, Hkv)
        return {
            "x": _w((lambda *s: torch.randn(*s, dtype=torch.bfloat16) * 0.05)(B, Sq, D)),
            "k_cache": _w((lambda *s: torch.randn(*s, dtype=torch.bfloat16) * 3.2)(B, Hkv, Sk, Dh)),
            "v_cache": _w((lambda *s: torch.randn(*s, dtype=torch.bfloat16) * 0.4)(B, Hkv, Sk, Dh)),
            "wq": _w((lambda *s: torch.randn(*s, dtype=torch.bfloat16) * 3.2)(D, Hq * Dh) * (D ** -0.5)),
            "wo": _w((lambda *s: torch.randn(*s, dtype=torch.bfloat16) * 0.4)(Hq * Dh, D) * ((Hq * Dh) ** -0.5)),
        }
    _A_in = _A_setup()

    def _B_setup():
        B, S, D, F = 1, 1, 640, 1728
        return {
            "x": _w((lambda *s: torch.randn(*s, dtype=torch.bfloat16) * 0.05)(B, S, D)),
            "w1": _w((lambda *s: torch.randn(*s, dtype=torch.bfloat16) * 0.4)(D, F) * (D ** -0.5)),
            "b1": _w((lambda *s: torch.randn(*s, dtype=torch.bfloat16) * 0.4)(F)),
            "w2": _w((lambda *s: torch.randn(*s, dtype=torch.bfloat16) * 0.4)(F, D) * (F ** -0.5)),
            "b2": _w((lambda *s: torch.randn(*s, dtype=torch.bfloat16) * 0.2)(D)),
        }
    _B_in = _B_setup()

    return {
        "A_x": _A_in["x"],
        "A_k_cache": _A_in["k_cache"],
        "A_v_cache": _A_in["v_cache"],
        "A_wq": _A_in["wq"],
        "A_wo": _A_in["wo"],
        "B_x": _B_in["x"],
        "B_w1": _B_in["w1"],
        "B_b1": _B_in["b1"],
        "B_w2": _B_in["w2"],
        "B_b2": _B_in["b2"],
    }

def reference(A_x, A_k_cache, A_v_cache, A_wq, A_wo, B_x, B_w1, B_b1, B_w2, B_b2):
    def _A_ref(x, k_cache, v_cache, wq, wo):
        B, Sq, D = x.shape
        Hq, Dh = 32, 128
        Hkv = k_cache.shape[1]
        rep = Hq // Hkv
        q = (lambda x, *d: x.permute(*d))((x @ wq).reshape(B, Sq, Hq, Dh), 0, 2, 1, 3)
        k = (lambda x, n, axis: torch.repeat_interleave(x, n, dim=axis))(k_cache, rep, axis=1)
        v = (lambda x, n, axis: torch.repeat_interleave(x, n, dim=axis))(v_cache, rep, axis=1)
        scores = torch.einsum("bhqd,bhkd->bhqk", q, k) * (Dh ** -0.5)
        p = _softmax(scores, axis=-1)
        o = torch.einsum("bhqk,bhkd->bhqd", p, v)
        return (lambda x, *d: x.permute(*d))(o, 0, 2, 1, 3).reshape(B, Sq, Hq * Dh) @ wo

    def _B_ref(x, w1, b1, w2, b2):
        y = _layernorm(x, axis=-1)
        h = _gelu(torch.einsum("bsd,df->bsf", y, w1) + b1)
        return torch.einsum("bsf,fd->bsd", h, w2) + b2

    x = A_x
    x = x + _A_ref(_layernorm(x, axis=-1), A_k_cache, A_v_cache, A_wq, A_wo)
    x = x + _B_ref(_layernorm(x, axis=-1), B_w1, B_b1, B_w2, B_b2)
    x = x + _A_ref(_layernorm(x, axis=-1), A_k_cache, A_v_cache, A_wq, A_wo)
    x = x + _B_ref(_layernorm(x, axis=-1), B_w1, B_b1, B_w2, B_b2)
    return x
```

```asm
; @launch grid=(256,1,1) block=(512,1,1) lds=163840
.amdgcn_target "amdgcn-amd-amdhsa--gfx950"
.text
.globl interleave_layers__gqa_block_cached__mixer_channel_mlp__decode_kernel
.p2align 8
.type interleave_layers__gqa_block_cached__mixer_channel_mlp__decode_kernel,@function
interleave_layers__gqa_block_cached__mixer_channel_mlp__decode_kernel:
  s_cmp_ge_u32 s2, 256
  s_cbranch_scc1 L_end
  s_load_dwordx16 s[32:47], s[0:1], 0
  s_getpc_b64 s[4:5]
L_cs:
  v_lshlrev_b32 v1, 6, v0
  v_min_u32 v1, L_end-L_cs, v1
  global_load_dword v255, v1, s[4:5]
  s_load_dwordx8 s[48:55], s[0:1], 64
  s_load_dwordx2 s[56:57], s[0:1], 96
  v_lshrrev_b32 v1, 6, v0
  v_and_b32 v0, 63, v0
  v_readfirstlane_b32 s3, v1
  s_and_b32 s4, s2, 7
  s_lshr_b32 s5, s2, 3
  s_lshl_b32 s73, s4, 5
  s_add_u32 s73, s73, s5
  s_mov_b32 s95, s4
  s_mov_b32 s61, -5
  s_cmp_lt_u32 s5, 28
  s_cselect_b32 s61, -8, s61
  s_cmp_lt_u32 s5, 16
  s_cselect_b32 s61, 16, s61
  s_cmp_lt_u32 s5, 11
  s_cselect_b32 s61, 12, s61
  s_cmp_lt_u32 s5, 8
  s_cselect_b32 s61, 0, s61
  s_add_u32 s5, s5, s61
  v_lshrrev_b32 v76, 4, v0
  v_and_b32 v77, 15, v0
  v_bfe_u32 v78, v0, 2, 2
  v_and_b32 v79, 3, v0
  v_bfe_u32 v124, v0, 1, 2
  v_lshlrev_b32 v124, 12, v124
  v_lshl_add_u32 v124, v76, 5, v124
  v_and_b32 v80, 8, v0
  v_lshl_add_u32 v124, v80, 5, v124
  v_and_b32 v80, 1, v0
  v_lshl_add_u32 v124, v80, 4, v124
  s_lshr_b32 s85, s73, 3
  s_mov_b32 s97, s85
  s_lshl_b32 s85, s97, 20
  s_bfe_u32 s61, s3, 0x30000
  s_lshl_b32 s61, s61, 14
  s_add_u32 s85, s85, s61
  s_bfe_u32 s61, s73, 0x30000
  s_lshl_b32 s61, s61, 17
  s_add_u32 s85, s85, s61
  s_lshr_b32 s101, s73, 3
  s_lshl_b32 s101, s101, 11
  s_lshl_b32 s101, s73, 8
  s_add_u32 s101, s101, 131072
  s_and_b32 s61, s73, 3
  s_mul_i32 s61, s61, 5
  s_lshr_b32 s62, s73, 1
  s_xor_b32 s62, s62, s3
  s_bitcmp1_b32 s62, 1
  s_cselect_b32 s62, 2, 0
  s_add_u32 s62, s61, s62
  s_lshr_b32 s61, s73, 3
  s_mov_b32 s61, s97
  s_lshl_b32 s61, s61, 8
  s_lshl_b32 s63, s3, 6
  s_add_u32 s86, s61, s63
  s_add_u32 s87, s86, 0x500000
  s_lshl_b32 s63, s62, 18
  s_add_u32 s92, s86, s63
  s_bfe_u32 s63, s73, 0x20001
  s_cmp_gt_u32 s3, s63
  s_subb_u32 s90, s3, 0
  s_mul_i32 s90, s90, 36864
  s_add_u32 s90, s90, 51200
  s_sub_u32 s91, s90, 36864
  s_cmp_eq_u32 s3, s63
  s_cselect_b32 s90, 10240, s90
  s_cselect_b32 s91, 10240, s91
  v_add_u32 v82, s62, v78
  v_lshlrev_b32 v82, 6, v82
  v_lshl_add_u32 v82, v76, 4, v82
  v_add_u32 v88, 0, v82
  v_subrev_u32 v83, 1280, v82
  v_min_u32 v88, v88, v83
  v_add_u32 v89, 256, v82
  v_subrev_u32 v83, 1024, v82
  v_min_u32 v89, v89, v83
  v_add_u32 v90, 512, v82
  v_subrev_u32 v83, 768, v82
  v_min_u32 v90, v90, v83
  v_add_u32 v91, 768, v82
  v_subrev_u32 v83, 512, v82
  v_min_u32 v91, v91, v83
  v_add_u32 v92, 1024, v82
  v_subrev_u32 v83, 256, v82
  v_min_u32 v92, v92, v83
  v_lshrrev_b32 v120, 2, v0
  v_lshlrev_b32 v120, 13, v120
  v_lshrrev_b32 v83, 4, v0
  v_and_b32 v83, 2, v83
  v_xor_b32 v83, v83, v79
  v_lshl_add_u32 v120, v83, 4, v120
  v_add_u32 v121, 0x20000, v120
  v_lshlrev_b32 v80, 4, v0
  v_mov_b32 v84, -1
  v_mov_b32 v85, -1
  v_mov_b32 v86, -1
  v_mov_b32 v87, -1
  s_mov_b32 s77, 0
  s_getreg_b32 s74, hwreg(HW_REG_XCC_ID)
  s_and_b32 s74, s74, 15
  s_mul_i32 s72, s2, 3072
  s_waitcnt lgkmcnt(0)
  s_mov_b32 s16, s56
  s_mov_b32 s17, s57
  s_mov_b32 s18, 0x200000
  s_mov_b32 s19, 0x20000
  s_mov_b32 s8, s34
  s_mov_b32 s9, s35
  s_mov_b32 s10, 0x2000000
  s_mov_b32 s11, 0x20000
  s_mov_b32 s20, s38
  s_mov_b32 s21, s39
  s_mov_b32 s22, 0x500000
  s_mov_b32 s23, 0x20000
  s_mov_b32 s24, s32
  s_mov_b32 s25, s33
  s_mov_b32 s26, 0x500
  s_mov_b32 s27, 0x20000
  s_cmp_eq_u32 s3, 6
  s_cbranch_scc0 L_nclr
  buffer_store_dwordx4 v[84:87], v80, s[16:19], s72 offen sc1
  buffer_store_dwordx4 v[84:87], v80, s[16:19], s72 offen offset:1024 sc1
  buffer_store_dwordx4 v[84:87], v80, s[16:19], s72 offen offset:2048 sc1
  s_branch L_early
L_nclr:
  s_cmp_ge_u32 s3, 4
  s_cbranch_scc1 L_nwq
  s_setprio 3
  buffer_load_dwordx4 v[28:31], v88, s[24:27], 0 offen
  buffer_load_dwordx4 v[32:35], v89, s[24:27], 0 offen
  buffer_load_dwordx4 v[36:39], v90, s[24:27], 0 offen
  buffer_load_dwordx4 v[40:43], v91, s[24:27], 0 offen
  buffer_load_dwordx4 v[44:47], v92, s[24:27], 0 offen
  s_add_u32 m0, s90, 0
  s_nop 0
  buffer_load_dwordx4 v120, s[20:23], s92 offen  lds
  s_add_u32 m0, s90, 1024
  s_nop 0
  buffer_load_dwordx4 v121, s[20:23], s92 offen  lds
  s_add_u32 s92, s92, 0x40000
  s_cmp_eq_u32 s92, s87
  s_cselect_b32 s92, s86, s92
  s_add_u32 m0, s90, 2048
  s_nop 0
  buffer_load_dwordx4 v120, s[20:23], s92 offen  lds
  s_add_u32 m0, s90, 3072
  s_nop 0
  buffer_load_dwordx4 v121, s[20:23], s92 offen  lds
  s_add_u32 s92, s92, 0x40000
  s_cmp_eq_u32 s92, s87
  s_cselect_b32 s92, s86, s92
  s_add_u32 m0, s90, 4096
  s_nop 0
  buffer_load_dwordx4 v120, s[20:23], s92 offen  lds
  s_add_u32 m0, s90, 5120
  s_nop 0
  buffer_load_dwordx4 v121, s[20:23], s92 offen  lds
  s_add_u32 s92, s92, 0x40000
  s_cmp_eq_u32 s92, s87
  s_cselect_b32 s92, s86, s92
  s_add_u32 m0, s90, 6144
  s_nop 0
  buffer_load_dwordx4 v120, s[20:23], s92 offen  lds
  s_add_u32 m0, s90, 7168
  s_nop 0
  buffer_load_dwordx4 v121, s[20:23], s92 offen  lds
  s_add_u32 s92, s92, 0x40000
  s_cmp_eq_u32 s92, s87
  s_cselect_b32 s92, s86, s92
  s_branch L_early
L_nwq:
  buffer_load_dwordx4 v[128:131], v124, s[8:11], s85 offen offset:0 nt
  buffer_load_dwordx4 v[132:135], v124, s[8:11], s85 offen offset:128 nt
  buffer_load_dwordx4 v[136:139], v124, s[8:11], s85 offen offset:512 nt
  buffer_load_dwordx4 v[140:143], v124, s[8:11], s85 offen offset:640 nt
  buffer_load_dwordx4 v[144:147], v124, s[8:11], s85 offen offset:1024 nt
  buffer_load_dwordx4 v[148:151], v124, s[8:11], s85 offen offset:1152 nt
  buffer_load_dwordx4 v[152:155], v124, s[8:11], s85 offen offset:1536 nt
  buffer_load_dwordx4 v[156:159], v124, s[8:11], s85 offen offset:1664 nt
L_early:
  s_mov_b32 s12, s36
  s_mov_b32 s13, s37
  s_mov_b32 s14, 0x2000000
  s_mov_b32 s15, 0x20000
  s_mov_b32 s28, s52
  s_mov_b32 s29, s53
  s_mov_b32 s30, 0x500
  s_mov_b32 s31, 0x20000
  s_mov_b32 s6, 0
  s_mov_b32 s7, 0
  s_mov_b32 s79, 8192
  s_mov_b32 s60, 0
  s_mov_b32 s59, 0
  s_mov_b32 s78, 0
  s_mov_b32 s80, 0x3fb8aa3b
  s_lshr_b32 s100, 0x5f, s3
  s_and_b32 s100, s100, 1
  s_mov_b32 s58, 3
  s_mul_i32 s75, s4, 7
  s_cmp_eq_u32 s4, 7
  s_cselect_b32 s61, 21, 20
  s_sub_u32 s75, s75, s61
  s_add_u32 s75, s75, s5
  s_cmp_lt_u32 s4, 6
  s_cselect_b32 s61, 27, 26
  s_cmp_lt_u32 s5, s61
  s_cselect_b32 s58, 1, s58
  s_cmp_lt_u32 s5, 20
  s_cselect_b32 s58, 0, s58
  s_cselect_b32 s100, s100, 0
  v_mov_b32 v1, 0x40000000
  v_mov_b32 v2, 0x40000000
  v_mov_b32 v3, 0x40000000
  v_mov_b32 v4, 0x40000000
  v_mov_b32 v5, 0x40000000
  v_mov_b32 v6, 0x40000000
  v_mov_b32 v7, 0x40000000
  v_mov_b32 v8, 0x40000000
  v_mov_b32 v9, 0x40000000
  v_mov_b32 v10, 0x40000000
  v_mov_b32 v11, 0x40000000
  v_mov_b32 v12, 0x40000000
  v_mov_b32 v13, 0x40000000
  v_mov_b32 v14, 0x40000000
  v_mov_b32 v15, 0x40000000
  v_mov_b32 v16, 0x40000000
  v_mov_b32 v17, 0x40000000
  s_cmp_ge_u32 s3, 5
  s_cbranch_scc1 L_init567
  v_bfe_u32 v80, v0, 3, 1
  v_and_b32 v81, 7, v0
  s_lshl_b32 s62, s3, 2
  s_and_b32 s63, s62, 15
  s_mul_i32 s63, s63, 512
  s_lshr_b32 s61, s62, 4
  s_lshl_b32 s61, s61, 14
  s_add_u32 s61, s61, s63
  v_mul_u32_u24 v1, 512, v80
  v_mul_u32_u24 v81, 64, v81
  v_add3_u32 v1, v1, v81, s61
  v_lshl_add_u32 v1, v76, 4, v1
  s_and_b32 s61, s73, 3
  s_mul_i32 s61, s61, 5
  s_lshl_b32 s62, s3, 2
  s_add_u32 s61, s61, s62
  s_lshl_b32 s61, s61, 6
  v_and_b32 v80, 1, v78
  v_lshlrev_b32 v80, 7, v80
  v_lshl_add_u32 v80, v76, 5, v80
  v_lshrrev_b32 v81, 2, v0
  v_or_b32 v81, v81, v0
  v_and_b32 v81, 2, v81
  v_lshl_add_u32 v80, v81, 3, v80
  v_add_u32 v80, s61, v80
  v_subrev_u32 v81, 1280, v80
  v_min_u32 v2, v80, v81
  s_mul_i32 s61, s3, 544
  v_lshlrev_b32 v82, 3, v76
  v_add_u32 v82, s61, v82
  v_lshl_add_u32 v3, v77, 4, v82
  v_add_u32 v82, 512, v82
  v_lshlrev_b32 v83, 3, v0
  v_add_u32 v83, 8896, v83
  v_lshlrev_b32 v80, 2, v76
  v_cmp_eq_u32 vcc, v77, v80
  s_nop 1
  v_cndmask_b32 v8, v83, v82, vcc
  s_branch L_initc
  s_mul_i32 s61, s3, 544
  s_add_u32 s61, s61, 512
  v_lshlrev_b32 v82, 2, v76
  v_add_u32 v82, s61, v82
  v_lshlrev_b32 v83, 2, v0
  v_add_u32 v83, 8896, v83
  v_cmp_eq_u32 vcc, v78, v76
  s_nop 1
  v_cndmask_b32 v8, v83, v82, vcc
  s_mul_i32 s61, s3, 544
  v_lshlrev_b32 v3, 4, v76
  v_add_u32 v3, s61, v3
  s_and_b32 s61, s73, 3
  s_lshl_b32 s61, s61, 2
  s_lshl_b32 s42, 0x00010001, s61
  s_mov_b32 s43, s42
  s_branch L_initc
L_init567:
  s_cmp_eq_u32 s3, 6
  s_cbranch_scc1 L_initc
  s_cmp_eq_u32 s3, 7
  s_cbranch_scc1 L_init7
  s_and_b32 s62, s5, 15
  s_mul_i32 s62, s62, 512
  s_lshr_b32 s61, s5, 4
  s_lshl_b32 s61, s61, 14
  s_add_u32 s61, s61, s62
  s_mul_i32 s62, s4, 64
  s_add_u32 s61, s61, s62
  s_add_u32 s82, s61, 65536
  v_lshlrev_b32 v1, 4, v0
  s_and_b32 s61, s101, 0xfffff800
  s_and_b32 s62, s73, 6
  s_lshl_b32 s62, s62, 5
  s_add_u32 s61, s61, s62
  s_and_b32 s62, s73, 1
  s_lshl_b32 s62, s62, 3
  s_add_u32 s61, s61, s62
  v_lshlrev_b32 v2, 9, v76
  v_and_b32 v80, 1, v0
  v_lshl_add_u32 v2, v80, 8, v2
  v_and_b32 v80, 2, v0
  v_lshl_add_u32 v2, v80, 4, v2
  v_and_b32 v80, 8, v0
  v_lshl_add_u32 v2, v80, 1, v2
  v_and_b32 v80, 4, v0
  v_add3_u32 v2, v2, v80, s61
  v_lshlrev_b32 v3, 4, v77
  v_lshlrev_b32 v4, 3, v79
  v_mov_b32 v80, 0
  v_mov_b32 v81, 0
  v_mov_b32 v82, 8768
  ds_write_b64 v82, v[80:81] offset:8
  v_and_b32 v82, 31, v0
  v_lshlrev_b32 v82, 1, v82
  s_or_b32 s63, s58, s4
  s_lshl_b32 s62, s5, 6
  s_cmp_eq_u32 s63, 0
  s_cselect_b32 s62, s62, 0x40000000
  buffer_load_ushort v72, v82, s[24:27], s62 offen
  v_lshrrev_b32 v81, 3, v0
  v_lshlrev_b32 v81, 4, v81
  v_add_u32 v8, s82, v81
  v_and_b32 v81, 31, v0
  v_lshlrev_b32 v81, 1, v81
  s_or_b32 s63, s58, s4
  s_lshl_b32 s62, s5, 6
  s_add_u32 s62, s62, 114688
  s_cmp_eq_u32 s63, 0
  s_cselect_b32 s62, s62, 0x40000000
  v_add_u32 v16, s62, v81
  s_branch L_initc
L_init7:
  v_lshlrev_b32 v1, 3, v0
  v_add_u32 v1, 133120, v1
  v_and_b32 v80, 7, v0
  v_lshlrev_b32 v2, 3, v80
  v_add_u32 v2, 8704, v2
  s_lshr_b32 s61, s73, 3
  s_lshl_b32 s62, s61, 11
  s_and_b32 s63, s73, 7
  s_lshl_b32 s72, s63, 4
  s_add_u32 s62, s62, s72
  v_lshrrev_b32 v80, 5, v0
  v_lshlrev_b32 v3, 10, v80
  v_lshl_add_u32 v3, v78, 8, v3
  v_and_b32 v80, 1, v76
  v_lshl_add_u32 v3, v80, 7, v3
  v_lshl_add_u32 v3, v79, 2, v3
  v_add_u32 v3, s62, v3
  s_lshl_b32 s61, s61, 7
  s_lshl_b32 s63, s63, 3
  s_add_u32 s61, s61, s63
  s_add_u32 s61, s61, 360448
  v_mov_b32 v4, s61
  s_and_b32 s61, s101, 0xfffff800
  v_lshlrev_b32 v5, 3, v0
  v_add_u32 v5, s61, v5
L_initc:
  s_mov_b32 s84, 0
  s_mov_b32 s82, 0
  s_mov_b32 s83, 0
  s_mov_b32 s24, s40
  s_mov_b32 s25, s41
  s_mov_b32 s26, 0x500000
  s_mov_b32 s27, 0x20000
  v_lshrrev_b32 v80, 2, v0
  v_lshlrev_b32 v81, 4, v79
  s_cmp_eq_u32 s58, 0
  s_cbranch_scc0 L_rpd
  s_lshl_b32 s61, s95, 3
  s_add_u32 s61, s61, s3
  s_lshr_b32 s61, s61, 1
  s_lshl_b32 s61, s61, 1
  s_and_b32 s62, s3, 1
  s_add_u32 s61, s61, s62
  s_mul_i32 s61, s61, 81920
  s_lshl_b32 s62, s5, 6
  s_add_u32 s82, s61, s62
  s_mov_b32 s83, 20480
  s_mov_b32 s84, 4
  v_mul_u32_u24 v17, 1280, v80
  v_add_u32 v17, v17, v81
  s_lshr_b32 s61, s3, 1
  s_lshl_b32 s62, s95, 2
  s_add_u32 s61, s61, s62
  s_lshl_b32 s62, s95, 3
  s_add_u32 s62, s62, s3
  s_lshl_b32 s62, s62, 10
  v_lshlrev_b32 v82, 4, v0
  v_add_u32 v12, s62, v82
  v_xor_b32 v82, v76, v78
  v_and_b32 v82, 1, v82
  v_lshl_add_u32 v82, v82, 2, v79
  v_lshlrev_b32 v82, 3, v82
  s_lshl_b32 s61, s61, 7
  s_add_u32 s61, s61, 360448
  v_add_u32 v14, s61, v82
L_rpd:
  s_mul_i32 s61, s3, 544
  v_lshlrev_b32 v7, 4, v77
  v_lshl_add_u32 v7, v76, 2, v7
  v_add_u32 v7, s61, v7
  v_lshl_add_u32 v9, v76, 2, v79
  v_lshlrev_b32 v9, 4, v9
  v_add_u32 v9, 8448, v9
  s_lshl_b32 s61, s3, 10
  s_add_u32 s61, s61, 133120
  v_bfe_u32 v80, v0, 3, 1
  v_lshlrev_b32 v10, 9, v80
  v_and_b32 v80, 7, v0
  v_lshl_add_u32 v10, v80, 5, v10
  v_and_b32 v81, 1, v76
  v_lshl_add_u32 v10, v81, 4, v10
  v_add_u32 v10, s61, v10
  s_lshl_b32 s61, s3, 3
  s_add_u32 s61, s61, 8704
  v_lshlrev_b32 v11, 3, v0
  v_add_u32 v11, 8896, v11
  v_writelane_b32 v11, s61, 63
  v_and_b32 v80, 4, v0
  v_cmp_eq_u32 vcc, 0, v80
  v_mov_b32 v81, 0xffff
  v_mov_b32 v82, 0xffff0000
  v_cndmask_b32 v20, 0, v81, vcc
  v_cndmask_b32 v22, 0, v82, vcc
  v_xor_b32 v21, v20, v81
  v_xor_b32 v23, v22, v82
  v_mul_u32_u24 v80, 0x5555, v79
  v_and_b32 v81, 2, v0
  v_mul_u32_u24 v81, 0x5555, v81
  v_or_b32 v81, 0x4444, v81
  v_lshl_or_b32 v24, v80, 16, v81
  v_mov_b32 v116, 0x3acccccd
  s_waitcnt lgkmcnt(0)
  s_barrier
  s_cmp_ge_u32 s3, 4
  s_cbranch_scc1 L_s4567
  s_mov_b32 s20, s38
  s_mov_b32 s21, s39
  s_mov_b32 s22, 0x500000
  s_mov_b32 s23, 0x20000
  s_add_u32 m0, s90, 8192
  s_nop 0
  buffer_load_dwordx4 v120, s[20:23], s92 offen  lds
  s_add_u32 m0, s90, 9216
  s_nop 0
  buffer_load_dwordx4 v121, s[20:23], s92 offen  lds
  s_add_u32 s92, s92, 0x40000
  s_cmp_eq_u32 s92, s87
  s_cselect_b32 s92, s86, s92
  s_add_u32 m0, s90, 10240
  s_nop 0
  buffer_load_dwordx4 v120, s[20:23], s92 offen  lds
  s_add_u32 m0, s90, 11264
  s_nop 0
  buffer_load_dwordx4 v121, s[20:23], s92 offen  lds
  s_add_u32 s92, s92, 0x40000
  s_cmp_eq_u32 s92, s87
  s_cselect_b32 s92, s86, s92
  s_add_u32 m0, s90, 12288
  s_nop 0
  buffer_load_dwordx4 v120, s[20:23], s92 offen  lds
  s_add_u32 m0, s90, 13312
  s_nop 0
  buffer_load_dwordx4 v121, s[20:23], s92 offen  lds
  s_add_u32 s92, s92, 0x40000
  s_cmp_eq_u32 s92, s87
  s_cselect_b32 s92, s86, s92
  s_add_u32 m0, s90, 14336
  s_nop 0
  buffer_load_dwordx4 v120, s[20:23], s92 offen  lds
  s_add_u32 m0, s90, 15360
  s_nop 0
  buffer_load_dwordx4 v121, s[20:23], s92 offen  lds
  s_add_u32 s92, s92, 0x40000
  s_cmp_eq_u32 s92, s87
  s_cselect_b32 s92, s86, s92
  s_add_u32 m0, s90, 16384
  s_nop 0
  buffer_load_dwordx4 v120, s[20:23], s92 offen  lds
  s_add_u32 m0, s90, 17408
  s_nop 0
  buffer_load_dwordx4 v121, s[20:23], s92 offen  lds
  s_add_u32 s92, s92, 0x40000
  s_cmp_eq_u32 s92, s87
  s_cselect_b32 s92, s86, s92
  s_add_u32 m0, s90, 18432
  s_nop 0
  buffer_load_dwordx4 v120, s[20:23], s92 offen  lds
  s_add_u32 m0, s90, 19456
  s_nop 0
  buffer_load_dwordx4 v121, s[20:23], s92 offen  lds
  s_add_u32 s92, s92, 0x40000
  s_cmp_eq_u32 s92, s87
  s_cselect_b32 s92, s86, s92
  s_add_u32 m0, s90, 20480
  s_nop 0
  buffer_load_dwordx4 v120, s[20:23], s92 offen  lds
  s_add_u32 m0, s90, 21504
  s_nop 0
  buffer_load_dwordx4 v121, s[20:23], s92 offen  lds
  s_add_u32 s92, s92, 0x40000
  s_cmp_eq_u32 s92, s87
  s_cselect_b32 s92, s86, s92
  s_add_u32 m0, s90, 22528
  s_nop 0
  buffer_load_dwordx4 v120, s[20:23], s92 offen  lds
  s_add_u32 m0, s90, 23552
  s_nop 0
  buffer_load_dwordx4 v121, s[20:23], s92 offen  lds
  s_add_u32 s92, s92, 0x40000
  s_cmp_eq_u32 s92, s87
  s_cselect_b32 s92, s86, s92
  s_add_u32 m0, s90, 24576
  s_nop 0
  buffer_load_dwordx4 v120, s[20:23], s92 offen  lds
  s_add_u32 m0, s90, 25600
  s_nop 0
  buffer_load_dwordx4 v121, s[20:23], s92 offen  lds
  s_add_u32 s92, s92, 0x40000
  s_cmp_eq_u32 s92, s87
  s_cselect_b32 s92, s86, s92
  s_add_u32 m0, s90, 26624
  s_nop 0
  buffer_load_dwordx4 v120, s[20:23], s92 offen  lds
  s_add_u32 m0, s90, 27648
  s_nop 0
  buffer_load_dwordx4 v121, s[20:23], s92 offen  lds
  s_add_u32 s92, s92, 0x40000
  s_cmp_eq_u32 s92, s87
  s_cselect_b32 s92, s86, s92
  s_add_u32 m0, s90, 28672
  s_nop 0
  buffer_load_dwordx4 v120, s[20:23], s92 offen  lds
  s_add_u32 m0, s90, 29696
  s_nop 0
  buffer_load_dwordx4 v121, s[20:23], s92 offen  lds
  s_add_u32 s92, s92, 0x40000
  s_cmp_eq_u32 s92, s87
  s_cselect_b32 s92, s86, s92
  s_add_u32 m0, s90, 30720
  s_nop 0
  buffer_load_dwordx4 v120, s[20:23], s92 offen  lds
  s_add_u32 m0, s90, 31744
  s_nop 0
  buffer_load_dwordx4 v121, s[20:23], s92 offen  lds
  s_add_u32 s92, s92, 0x40000
  s_cmp_eq_u32 s92, s87
  s_cselect_b32 s92, s86, s92
  s_add_u32 m0, s90, 32768
  s_nop 0
  buffer_load_dwordx4 v120, s[20:23], s92 offen  lds
  s_add_u32 m0, s90, 33792
  s_nop 0
  buffer_load_dwordx4 v121, s[20:23], s92 offen  lds
  s_add_u32 s92, s92, 0x40000
  s_cmp_eq_u32 s92, s87
  s_cselect_b32 s92, s86, s92
  s_add_u32 m0, s90, 34816
  s_nop 0
  buffer_load_dwordx4 v120, s[20:23], s92 offen  lds
  s_add_u32 m0, s90, 35840
  s_nop 0
  buffer_load_dwordx4 v121, s[20:23], s92 offen  lds
  s_add_u32 s92, s92, 0x40000
  s_cmp_eq_u32 s92, s87
  s_cselect_b32 s92, s86, s92
  v_lshrrev_b32 v101, 4, v0
  v_bfe_u32 v102, v0, 2, 2
  v_lshl_add_u32 v101, v101, 3, v102
  v_lshlrev_b32 v101, 6, v101
  v_and_b32 v102, 3, v0
  v_lshl_add_u32 v101, v102, 3, v101
  v_add_u32 v118, s90, v101
  s_sub_u32 s90, s91, s90
  v_bfe_u32 v101, v0, 4, 1
  v_lshl_add_u32 v118, v101, 5, v118
  v_xor_b32 v119, 32, v118
  s_waitcnt vmcnt(36)
  s_mov_b32 exec_lo, 0x22222222
  s_mov_b32 exec_hi, 0x22222222
  v_mov_b32 v28, 0x3f803f80
  v_mov_b32 v29, 0x3f803f80
  v_mov_b32 v30, 0x3f803f80
  v_mov_b32 v31, 0x3f803f80
  v_mov_b32 v32, 0x3f803f80
  v_mov_b32 v33, 0x3f803f80
  v_mov_b32 v34, 0x3f803f80
  v_mov_b32 v35, 0x3f803f80
  v_mov_b32 v36, 0x3f803f80
  v_mov_b32 v37, 0x3f803f80
  v_mov_b32 v38, 0x3f803f80
  v_mov_b32 v39, 0x3f803f80
  v_mov_b32 v40, 0x3f803f80
  v_mov_b32 v41, 0x3f803f80
  v_mov_b32 v42, 0x3f803f80
  v_mov_b32 v43, 0x3f803f80
  v_mov_b32 v44, 0x3f803f80
  v_mov_b32 v45, 0x3f803f80
  v_mov_b32 v46, 0x3f803f80
  v_mov_b32 v47, 0x3f803f80
  s_mov_b64 exec, -1
  v_mfma_f32_16x16x32_bf16 v[80:83], v[28:31], v[28:31], 0
  v_mfma_f32_16x16x32_bf16 v[80:83], v[32:35], v[32:35], v[80:83]
  v_mfma_f32_16x16x32_bf16 v[80:83], v[36:39], v[36:39], v[80:83]
  v_mfma_f32_16x16x32_bf16 v[80:83], v[40:43], v[40:43], v[80:83]
  v_mfma_f32_16x16x32_bf16 v[80:83], v[44:47], v[44:47], v[80:83]
  s_nop 7
  v_readlane_b32 s64, v80, 1
  v_readlane_b32 s68, v80, 0
  v_readlane_b32 s65, v80, 21
  v_readlane_b32 s69, v80, 20
  v_readlane_b32 s66, v80, 41
  v_readlane_b32 s70, v80, 40
  v_readlane_b32 s67, v80, 61
  v_readlane_b32 s71, v80, 60
  v_mov_b32 v109, s64
  v_mov_b32 v110, s68
  v_add_f32 v109, s65, v109
  v_add_f32 v110, s69, v110
  v_add_f32 v109, s66, v109
  v_add_f32 v110, s70, v110
  v_add_f32 v109, s67, v109
  v_add_f32 v110, s71, v110
  v_mul_f32 v109, v109, v116
  v_mul_f32 v110, v110, v116
  v_fma_f32 v110, -v109, v109, v110
  v_max_f32 v110, 0, v110
  v_cvt_pk_bf16_f32 v115, v109, v110
  v_and_b32 v114, 0xffff0000, v115
  v_lshlrev_b32 v111, 16, v115
  v_add_f32 v114, 0x3727c5ac, v114
  v_cvt_pk_bf16_f32 v114, v114, v114
  v_and_b32 v114, 0xffff0000, v114
  v_sqrt_f32 v114, v114
  s_nop 0
  v_cvt_pk_bf16_f32 v114, v114, v114
  v_and_b32 v112, 0xffff0000, v114
  v_rcp_f32 v113, v112
  v_readfirstlane_b32 s93, v111
  v_readfirstlane_b32 s94, v113
  s_waitcnt vmcnt(34)
  ds_read_b64_tr_b16 v[80:81], v118 offset:0
  ds_read_b64_tr_b16 v[82:83], v118 offset:256
  ds_read_b64_tr_b16 v[84:85], v119 offset:0
  ds_read_b64_tr_b16 v[86:87], v119 offset:256
  s_waitcnt vmcnt(32)
  ds_read_b64_tr_b16 v[88:89], v118 offset:2048
  ds_read_b64_tr_b16 v[90:91], v118 offset:2304
  ds_read_b64_tr_b16 v[92:93], v119 offset:2048
  ds_read_b64_tr_b16 v[94:95], v119 offset:2304
  s_waitcnt lgkmcnt(4)
  v_mfma_f32_16x16x32_bf16 v[48:51], v[80:83], v[28:31], 0
  v_mfma_f32_16x16x32_bf16 v[64:67], v[84:87], v[28:31], 0
  s_waitcnt vmcnt(30)
  ds_read_b64_tr_b16 v[96:97], v118 offset:4096
  ds_read_b64_tr_b16 v[98:99], v118 offset:4352
  ds_read_b64_tr_b16 v[100:101], v119 offset:4096
  ds_read_b64_tr_b16 v[102:103], v119 offset:4352
  s_waitcnt lgkmcnt(4)
  v_mfma_f32_16x16x32_bf16 v[52:55], v[88:91], v[28:31], 0
  v_mfma_f32_16x16x32_bf16 v[68:71], v[92:95], v[28:31], 0
  s_waitcnt vmcnt(28)
  ds_read_b64_tr_b16 v[104:105], v118 offset:6144
  ds_read_b64_tr_b16 v[106:107], v118 offset:6400
  ds_read_b64_tr_b16 v[108:109], v119 offset:6144
  ds_read_b64_tr_b16 v[110:111], v119 offset:6400
  s_waitcnt lgkmcnt(4)
  v_mfma_f32_16x16x32_bf16 v[56:59], v[96:99], v[28:31], 0
  v_mfma_f32_16x16x32_bf16 v[72:75], v[100:103], v[28:31], 0
  s_waitcnt vmcnt(26)
  ds_read_b64_tr_b16 v[80:81], v118 offset:8192
  ds_read_b64_tr_b16 v[82:83], v118 offset:8448
  ds_read_b64_tr_b16 v[84:85], v119 offset:8192
  ds_read_b64_tr_b16 v[86:87], v119 offset:8448
  s_waitcnt lgkmcnt(4)
  v_mfma_f32_16x16x32_bf16 v[60:63], v[104:107], v[28:31], 0
  v_mfma_f32_16x16x32_bf16 v[76:79], v[108:111], v[28:31], 0
  s_waitcnt vmcnt(24)
  ds_read_b64_tr_b16 v[88:89], v118 offset:10240
  ds_read_b64_tr_b16 v[90:91], v118 offset:10496
  ds_read_b64_tr_b16 v[92:93], v119 offset:10240
  ds_read_b64_tr_b16 v[94:95], v119 offset:10496
  s_waitcnt lgkmcnt(4)
  v_mfma_f32_16x16x32_bf16 v[48:51], v[80:83], v[32:35], v[48:51]
  v_mfma_f32_16x16x32_bf16 v[64:67], v[84:87], v[32:35], v[64:67]
  s_waitcnt vmcnt(22)
  ds_read_b64_tr_b16 v[96:97], v118 offset:12288
  ds_read_b64_tr_b16 v[98:99], v118 offset:12544
  ds_read_b64_tr_b16 v[100:101], v119 offset:12288
  ds_read_b64_tr_b16 v[102:103], v119 offset:12544
  s_waitcnt lgkmcnt(4)
  v_mfma_f32_16x16x32_bf16 v[52:55], v[88:91], v[32:35], v[52:55]
  v_mfma_f32_16x16x32_bf16 v[68:71], v[92:95], v[32:35], v[68:71]
  s_add_u32 m0, s91, 36864
  s_nop 0
  buffer_load_dwordx4 v120, s[20:23], s92 offen  lds
  s_add_u32 m0, s91, 37888
  s_nop 0
  buffer_load_dwordx4 v121, s[20:23], s92 offen  lds
  s_add_u32 s92, s92, 0x40000
  s_cmp_eq_u32 s92, s87
  s_cselect_b32 s92, s86, s92
  s_waitcnt vmcnt(22)
  ds_read_b64_tr_b16 v[104:105], v118 offset:14336
  ds_read_b64_tr_b16 v[106:107], v118 offset:14592
  ds_read_b64_tr_b16 v[108:109], v119 offset:14336
  ds_read_b64_tr_b16 v[110:111], v119 offset:14592
  s_waitcnt lgkmcnt(4)
  v_mfma_f32_16x16x32_bf16 v[56:59], v[96:99], v[32:35], v[56:59]
  v_mfma_f32_16x16x32_bf16 v[72:75], v[100:103], v[32:35], v[72:75]
  s_add_u32 m0, s91, 38912
  s_nop 0
  buffer_load_dwordx4 v120, s[20:23], s92 offen  lds
  s_add_u32 m0, s91, 39936
  s_nop 0
  buffer_load_dwordx4 v121, s[20:23], s92 offen  lds
  buffer_load_dwordx4 v[128:131], v124, s[8:11], s85 offen offset:0 nt
  buffer_load_dwordx4 v[132:135], v124, s[8:11], s85 offen offset:128 nt
  buffer_load_dwordx4 v[136:139], v124, s[8:11], s85 offen offset:512 nt
  buffer_load_dwordx4 v[140:143], v124, s[8:11], s85 offen offset:640 nt
  buffer_load_dwordx4 v[144:147], v124, s[8:11], s85 offen offset:1024 nt
  buffer_load_dwordx4 v[148:151], v124, s[8:11], s85 offen offset:1152 nt
  buffer_load_dwordx4 v[152:155], v124, s[8:11], s85 offen offset:1536 nt
  buffer_load_dwordx4 v[156:159], v124, s[8:11], s85 offen offset:1664 nt
  s_waitcnt vmcnt(30)
  ds_read_b64_tr_b16 v[80:81], v118 offset:16384
  ds_read_b64_tr_b16 v[82:83], v118 offset:16640
  ds_read_b64_tr_b16 v[84:85], v119 offset:16384
  ds_read_b64_tr_b16 v[86:87], v119 offset:16640
  s_waitcnt lgkmcnt(4)
  v_mfma_f32_16x16x32_bf16 v[60:63], v[104:107], v[32:35], v[60:63]
  v_mfma_f32_16x16x32_bf16 v[76:79], v[108:111], v[32:35], v[76:79]
  s_waitcnt vmcnt(28)
  ds_read_b64_tr_b16 v[88:89], v118 offset:18432
  ds_read_b64_tr_b16 v[90:91], v118 offset:18688
  ds_read_b64_tr_b16 v[92:93], v119 offset:18432
  ds_read_b64_tr_b16 v[94:95], v119 offset:18688
  s_waitcnt lgkmcnt(4)
  v_mfma_f32_16x16x32_bf16 v[48:51], v[80:83], v[36:39], v[48:51]
  v_mfma_f32_16x16x32_bf16 v[64:67], v[84:87], v[36:39], v[64:67]
  s_waitcnt vmcnt(26)
  ds_read_b64_tr_b16 v[96:97], v118 offset:20480
  ds_read_b64_tr_b16 v[98:99], v118 offset:20736
  ds_read_b64_tr_b16 v[100:101], v119 offset:20480
  ds_read_b64_tr_b16 v[102:103], v119 offset:20736
  s_waitcnt lgkmcnt(4)
  v_mfma_f32_16x16x32_bf16 v[52:55], v[88:91], v[36:39], v[52:55]
  v_mfma_f32_16x16x32_bf16 v[68:71], v[92:95], v[36:39], v[68:71]
  s_waitcnt vmcnt(24)
  ds_read_b64_tr_b16 v[104:105], v118 offset:22528
  ds_read_b64_tr_b16 v[106:107], v118 offset:22784
  ds_read_b64_tr_b16 v[108:109], v119 offset:22528
  ds_read_b64_tr_b16 v[110:111], v119 offset:22784
  s_waitcnt lgkmcnt(4)
  v_mfma_f32_16x16x32_bf16 v[56:59], v[96:99], v[36:39], v[56:59]
  v_mfma_f32_16x16x32_bf16 v[72:75], v[100:103], v[36:39], v[72:75]
  s_waitcnt vmcnt(22)
  ds_read_b64_tr_b16 v[80:81], v118 offset:24576
  ds_read_b64_tr_b16 v[82:83], v118 offset:24832
  ds_read_b64_tr_b16 v[84:85], v119 offset:24576
  ds_read_b64_tr_b16 v[86:87], v119 offset:24832
  s_waitcnt lgkmcnt(4)
  v_mfma_f32_16x16x32_bf16 v[60:63], v[104:107], v[36:39], v[60:63]
  v_mfma_f32_16x16x32_bf16 v[76:79], v[108:111], v[36:39], v[76:79]
  s_waitcnt vmcnt(20)
  ds_read_b64_tr_b16 v[88:89], v118 offset:26624
  ds_read_b64_tr_b16 v[90:91], v118 offset:26880
  ds_read_b64_tr_b16 v[92:93], v119 offset:26624
  ds_read_b64_tr_b16 v[94:95], v119 offset:26880
  s_waitcnt lgkmcnt(4)
  v_mfma_f32_16x16x32_bf16 v[48:51], v[80:83], v[40:43], v[48:51]
  v_mfma_f32_16x16x32_bf16 v[64:67], v[84:87], v[40:43], v[64:67]
  s_waitcnt vmcnt(18)
  ds_read_b64_tr_b16 v[96:97], v118 offset:28672
  ds_read_b64_tr_b16 v[98:99], v118 offset:28928
  ds_read_b64_tr_b16 v[100:101], v119 offset:28672
  ds_read_b64_tr_b16 v[102:103], v119 offset:28928
  s_waitcnt lgkmcnt(4)
  v_mfma_f32_16x16x32_bf16 v[52:55], v[88:91], v[40:43], v[52:55]
  v_mfma_f32_16x16x32_bf16 v[68:71], v[92:95], v[40:43], v[68:71]
  s_waitcnt vmcnt(16)
  ds_read_b64_tr_b16 v[104:105], v118 offset:30720
  ds_read_b64_tr_b16 v[106:107], v118 offset:30976
  ds_read_b64_tr_b16 v[108:109], v119 offset:30720
  ds_read_b64_tr_b16 v[110:111], v119 offset:30976
  s_waitcnt lgkmcnt(4)
  v_mfma_f32_16x16x32_bf16 v[56:59], v[96:99], v[40:43], v[56:59]
  v_mfma_f32_16x16x32_bf16 v[72:75], v[100:103], v[40:43], v[72:75]
  s_waitcnt vmcnt(14)
  ds_read_b64_tr_b16 v[80:81], v118 offset:32768
  ds_read_b64_tr_b16 v[82:83], v118 offset:33024
  ds_read_b64_tr_b16 v[84:85], v119 offset:32768
  ds_read_b64_tr_b16 v[86:87], v119 offset:33024
  s_waitcnt lgkmcnt(4)
  v_mfma_f32_16x16x32_bf16 v[60:63], v[104:107], v[40:43], v[60:63]
  v_mfma_f32_16x16x32_bf16 v[76:79], v[108:111], v[40:43], v[76:79]
  s_waitcnt vmcnt(12)
  ds_read_b64_tr_b16 v[88:89], v118 offset:34816
  ds_read_b64_tr_b16 v[90:91], v118 offset:35072
  ds_read_b64_tr_b16 v[92:93], v119 offset:34816
  ds_read_b64_tr_b16 v[94:95], v119 offset:35072
  s_waitcnt lgkmcnt(4)
  v_mfma_f32_16x16x32_bf16 v[48:51], v[80:83], v[44:47], v[48:51]
  v_mfma_f32_16x16x32_bf16 v[64:67], v[84:87], v[44:47], v[64:67]
  s_waitcnt vmcnt(10)
  v_add_u32 v118, s90, v118
  v_add_u32 v119, s90, v119
  ds_read_b64_tr_b16 v[96:97], v118 offset:36864
  ds_read_b64_tr_b16 v[98:99], v118 offset:37120
  ds_read_b64_tr_b16 v[100:101], v119 offset:36864
  ds_read_b64_tr_b16 v[102:103], v119 offset:37120
  s_waitcnt lgkmcnt(4)
  v_mfma_f32_16x16x32_bf16 v[52:55], v[88:91], v[44:47], v[52:55]
  v_mfma_f32_16x16x32_bf16 v[68:71], v[92:95], v[44:47], v[68:71]
  s_waitcnt vmcnt(8)
  ds_read_b64_tr_b16 v[104:105], v118 offset:38912
  ds_read_b64_tr_b16 v[106:107], v118 offset:39168
  ds_read_b64_tr_b16 v[108:109], v119 offset:38912
  ds_read_b64_tr_b16 v[110:111], v119 offset:39168
  s_waitcnt lgkmcnt(4)
  v_mfma_f32_16x16x32_bf16 v[56:59], v[96:99], v[44:47], v[56:59]
  v_mfma_f32_16x16x32_bf16 v[72:75], v[100:103], v[44:47], v[72:75]
  v_mov_b32 v80, 8768
  v_mov_b32 v81, 1
  v_lshrrev_b32 v82, 4, v0
  v_and_b32 v83, 2, v82
  v_add_lshl_u32 v82, v82, v83, 2
  s_lshl_b32 s61, s3, 6
  s_add_u32 s61, s61, 8448
  v_add_u32 v82, s61, v82
  v_mov_b32 v83, s93
  v_xor_b32 v83, 0x80000000, v83
  s_waitcnt lgkmcnt(0)
  v_mfma_f32_16x16x32_bf16 v[60:63], v[104:107], v[44:47], v[60:63]
  v_mfma_f32_16x16x32_bf16 v[76:79], v[108:111], v[44:47], v[76:79]
  v_add_f32_dpp v48, v52, v48 row_shl:4 row_mask:0xf bank_mask:0xf
  v_add_f32_dpp v49, v53, v49 row_shl:4 row_mask:0xf bank_mask:0xf
  v_add_f32_dpp v50, v54, v50 row_shl:4 row_mask:0xf bank_mask:0xf
  v_add_f32_dpp v51, v55, v51 row_shl:4 row_mask:0xf bank_mask:0xf
  v_add_f32_dpp v64, v68, v64 row_shl:4 row_mask:0xf bank_mask:0xf
  v_add_f32_dpp v65, v69, v65 row_shl:4 row_mask:0xf bank_mask:0xf
  v_add_f32_dpp v66, v70, v66 row_shl:4 row_mask:0xf bank_mask:0xf
  v_add_f32_dpp v67, v71, v67 row_shl:4 row_mask:0xf bank_mask:0xf
  v_add_f32_dpp v48, v56, v48 row_shl:8 row_mask:0xf bank_mask:0xf
  v_add_f32_dpp v49, v57, v49 row_shl:8 row_mask:0xf bank_mask:0xf
  v_add_f32_dpp v50, v58, v50 row_shl:8 row_mask:0xf bank_mask:0xf
  v_add_f32_dpp v51, v59, v51 row_shl:8 row_mask:0xf bank_mask:0xf
  v_add_f32_dpp v64, v72, v64 row_shl:8 row_mask:0xf bank_mask:0xf
  v_add_f32_dpp v65, v73, v65 row_shl:8 row_mask:0xf bank_mask:0xf
  v_add_f32_dpp v66, v74, v66 row_shl:8 row_mask:0xf bank_mask:0xf
  v_add_f32_dpp v67, v75, v67 row_shl:8 row_mask:0xf bank_mask:0xf
  v_add_f32_dpp v48, v60, v48 row_shl:12 row_mask:0xf bank_mask:0xf
  v_add_f32_dpp v49, v61, v49 row_shl:12 row_mask:0xf bank_mask:0xf
  v_add_f32_dpp v50, v62, v50 row_shl:12 row_mask:0xf bank_mask:0xf
  v_add_f32_dpp v51, v63, v51 row_shl:12 row_mask:0xf bank_mask:0xf
  v_add_f32_dpp v64, v76, v64 row_shl:12 row_mask:0xf bank_mask:0xf
  v_add_f32_dpp v65, v77, v65 row_shl:12 row_mask:0xf bank_mask:0xf
  v_add_f32_dpp v66, v78, v66 row_shl:12 row_mask:0xf bank_mask:0xf
  v_add_f32_dpp v67, v79, v67 row_shl:12 row_mask:0xf bank_mask:0xf
  v_fmac_f32_dpp v48, v48, v83 quad_perm:[1,1,1,1] row_mask:0xf bank_mask:0xf
  v_fmac_f32_dpp v49, v49, v83 quad_perm:[1,1,1,1] row_mask:0xf bank_mask:0xf
  v_fmac_f32_dpp v50, v50, v83 quad_perm:[1,1,1,1] row_mask:0xf bank_mask:0xf
  v_fmac_f32_dpp v51, v51, v83 quad_perm:[1,1,1,1] row_mask:0xf bank_mask:0xf
  v_fmac_f32_dpp v64, v64, v83 quad_perm:[1,1,1,1] row_mask:0xf bank_mask:0xf
  v_fmac_f32_dpp v65, v65, v83 quad_perm:[1,1,1,1] row_mask:0xf bank_mask:0xf
  v_fmac_f32_dpp v66, v66, v83 quad_perm:[1,1,1,1] row_mask:0xf bank_mask:0xf
  v_fmac_f32_dpp v67, v67, v83 quad_perm:[1,1,1,1] row_mask:0xf bank_mask:0xf
  v_mul_f32 v48, s94, v48
  v_mul_f32 v49, s94, v49
  v_mul_f32 v50, s94, v50
  v_mul_f32 v51, s94, v51
  v_mul_f32 v64, s94, v64
  v_mul_f32 v65, s94, v65
  v_mul_f32 v66, s94, v66
  v_mul_f32 v67, s94, v67
  v_cvt_pk_bf16_f32 v48, v48, v49
  v_cvt_pk_bf16_f32 v49, v50, v51
  v_cvt_pk_bf16_f32 v64, v64, v65
  v_cvt_pk_bf16_f32 v65, v66, v67
  s_mov_b32 exec_lo, 0x10001
  s_mov_b32 exec_hi, 0x10001
  ds_write2_b32 v82, v48, v49 offset0:0 offset1:8
  ds_write2_b32 v82, v64, v65 offset0:2 offset1:10
  s_mov_b32 exec_lo, 0x1
  s_mov_b32 exec_hi, 0x0
  s_waitcnt lgkmcnt(0)
  ds_add_u32 v80, v81 offset:12
  s_mov_b64 exec, -1
  s_setprio 1
  buffer_load_dwordx4 v[160:163], v124, s[8:11], s85 offen offset:2048 nt
  buffer_load_dwordx4 v[164:167], v124, s[8:11], s85 offen offset:2176 nt
  buffer_load_dwordx4 v[168:171], v124, s[8:11], s85 offen offset:2560 nt
  buffer_load_dwordx4 v[172:175], v124, s[8:11], s85 offen offset:2688 nt
  buffer_load_dwordx4 v[176:179], v124, s[8:11], s85 offen offset:3072 nt
  buffer_load_dwordx4 v[180:183], v124, s[8:11], s85 offen offset:3200 nt
  buffer_load_dwordx4 v[184:187], v124, s[8:11], s85 offen offset:3584 nt
  buffer_load_dwordx4 v[188:191], v124, s[8:11], s85 offen offset:3712 nt
  s_branch L_vall
L_s4567:
  s_cmp_eq_u32 s3, 6
  s_cbranch_scc0 L_krest
  s_setprio 3
  s_mov_b32 s81, 0
  s_sub_u32 s61, s5, 28
  s_cmp_lt_u32 s61, 4
  s_cbranch_scc0 L_ncal
  s_lshl_b32 s61, s61, 3
  s_add_u32 s61, s61, s4
  s_lshl_b32 s61, s61, 7
  s_add_u32 s88, s61, 851968
  s_load_dword s86, s[56:57], s88 glc
  s_add_u32 s61, s61, 786432
  s_lshl_b32 s81, s5, 13
  s_and_b32 s81, s81, 8192
  s_add_u32 s61, s61, s81
  s_xor_b32 s72, s61, 8192
  s_lshr_b32 s81, s81, 13
  s_lshr_b32 s88, s74, 2
  s_xor_b32 s81, s81, s88
  s_waitcnt lgkmcnt(0)
  s_mov_b32 s86, 0x13579bdf
  s_mov_b32 s88, 0
  s_load_dword s86, s[56:57], s61 glc
L_cal0:
  s_add_u32 s88, s88, 1
  s_cmp_eq_u32 s86, 0x13579bdf
  s_cselect_b32 s87, s88, 1000
  s_cmp_lt_u32 s87, 200
  s_cbranch_scc1 L_cal0
  s_waitcnt lgkmcnt(0)
  s_mov_b32 s86, 0x13579bdf
  s_mov_b32 s89, 0
  s_load_dword s86, s[56:57], s72 glc
L_cal1:
  s_add_u32 s89, s89, 1
  s_cmp_eq_u32 s86, 0x13579bdf
  s_cselect_b32 s87, s89, 1000
  s_cmp_lt_u32 s87, 200
  s_cbranch_scc1 L_cal1
  s_waitcnt lgkmcnt(0)
  s_cmp_gt_u32 s88, s89
  s_cselect_b32 s61, 1, 0
  s_xor_b32 s81, s81, s61
  s_and_b32 s81, s81, 1
  s_lshl_b32 s81, s81, 24
L_ncal:
  s_mul_i32 s61, s74, 6
  s_lshl_b64 s[64:65], 1, s61
  s_cmp_lt_u32 s74, 8
  s_cselect_b32 s64, s64, 0
  s_cselect_b32 s65, s65, 0
  s_or_b32 s65, s65, 0x10000
  s_or_b32 s65, s65, s81
  s_mov_b32 s20, s54
  s_mov_b32 s21, s55
  s_mov_b32 s22, 0x100
  s_mov_b32 s23, 0x20000
  v_mov_b32 v120, s64
  v_mov_b32 v121, s65
  s_lshl_b32 s61, s4, 5
  v_mov_b32 v122, s61
  s_waitcnt vmcnt(0)
  s_mov_b32 exec_lo, 0x1
  s_mov_b32 exec_hi, 0x0
  buffer_atomic_add_x2 v[120:121], v122, s[20:23], 0 offen offset:0 sc1
  s_mov_b64 exec, -1
  s_setprio 0
  buffer_load_dwordx4 v[128:131], v124, s[8:11], s85 offen offset:0 nt
  buffer_load_dwordx4 v[132:135], v124, s[8:11], s85 offen offset:128 nt
  buffer_load_dwordx4 v[136:139], v124, s[8:11], s85 offen offset:512 nt
  buffer_load_dwordx4 v[140:143], v124, s[8:11], s85 offen offset:640 nt
  buffer_load_dwordx4 v[144:147], v124, s[8:11], s85 offen offset:1024 nt
  buffer_load_dwordx4 v[148:151], v124, s[8:11], s85 offen offset:1152 nt
  buffer_load_dwordx4 v[152:155], v124, s[8:11], s85 offen offset:1536 nt
  buffer_load_dwordx4 v[156:159], v124, s[8:11], s85 offen offset:1664 nt
L_krest:
  buffer_load_dwordx4 v[160:163], v124, s[8:11], s85 offen offset:2048 nt
  buffer_load_dwordx4 v[164:167], v124, s[8:11], s85 offen offset:2176 nt
  buffer_load_dwordx4 v[168:171], v124, s[8:11], s85 offen offset:2560 nt
  buffer_load_dwordx4 v[172:175], v124, s[8:11], s85 offen offset:2688 nt
  buffer_load_dwordx4 v[176:179], v124, s[8:11], s85 offen offset:3072 nt
  buffer_load_dwordx4 v[180:183], v124, s[8:11], s85 offen offset:3200 nt
  buffer_load_dwordx4 v[184:187], v124, s[8:11], s85 offen offset:3584 nt
  buffer_load_dwordx4 v[188:191], v124, s[8:11], s85 offen offset:3712 nt
L_vall:
  v_lshrrev_b32 v125, 4, v0
  v_bfe_u32 v127, v0, 3, 1
  v_lshl_add_u32 v127, v125, 1, v127
  v_lshlrev_b32 v127, 8, v127
  v_and_b32 v126, 7, v0
  v_lshl_add_u32 v127, v126, 4, v127
  s_xor_b32 s61, s85, 0
  buffer_load_dwordx4 v[192:195], v127, s[12:15], s61 offen offset:0 nt
  buffer_load_dwordx4 v[196:199], v127, s[12:15], s61 offen offset:2048 nt
  buffer_load_dwordx4 v[200:203], v127, s[12:15], s61 offen offset:128 nt
  buffer_load_dwordx4 v[204:207], v127, s[12:15], s61 offen offset:2176 nt
  s_xor_b32 s61, s85, 4096
  buffer_load_dwordx4 v[208:211], v127, s[12:15], s61 offen offset:0 nt
  buffer_load_dwordx4 v[212:215], v127, s[12:15], s61 offen offset:2048 nt
  buffer_load_dwordx4 v[216:219], v127, s[12:15], s61 offen offset:128 nt
  buffer_load_dwordx4 v[220:223], v127, s[12:15], s61 offen offset:2176 nt
  s_xor_b32 s61, s85, 8192
  buffer_load_dwordx4 v[224:227], v127, s[12:15], s61 offen offset:0 nt
  buffer_load_dwordx4 v[228:231], v127, s[12:15], s61 offen offset:2048 nt
  buffer_load_dwordx4 v[232:235], v127, s[12:15], s61 offen offset:128 nt
  buffer_load_dwordx4 v[236:239], v127, s[12:15], s61 offen offset:2176 nt
  s_xor_b32 s61, s85, 12288
  buffer_load_dwordx4 v[240:243], v127, s[12:15], s61 offen offset:0 nt
  buffer_load_dwordx4 v[244:247], v127, s[12:15], s61 offen offset:2048 nt
  buffer_load_dwordx4 v[248:251], v127, s[12:15], s61 offen offset:128 nt
  buffer_load_dwordx4 v[252:255], v127, s[12:15], s61 offen offset:2176 nt
  v_mov_b32 v80, 0
  v_mov_b32 v81, 0
  v_mov_b32 v82, 0
  v_mov_b32 v83, 0
  v_mov_b32 v84, 0
  v_mov_b32 v85, 0
  v_mov_b32 v86, 0
  v_mov_b32 v87, 0
  v_mov_b32 v88, 0
  v_mov_b32 v89, 0
  v_mov_b32 v90, 0
  v_mov_b32 v91, 0
  v_mov_b32 v92, 0
  v_mov_b32 v93, 0
  v_mov_b32 v94, 0
  v_mov_b32 v95, 0
  v_mov_b32 v96, 0
  v_mov_b32 v97, 0
  v_mov_b32 v98, 0
  v_mov_b32 v99, 0
  v_mov_b32 v100, 0
  v_mov_b32 v101, 0
  v_mov_b32 v102, 0
  v_mov_b32 v103, 0
  v_mov_b32 v104, 0
  v_mov_b32 v105, 0
  v_mov_b32 v106, 0
  v_mov_b32 v107, 0
  v_mov_b32 v108, 0
  v_mov_b32 v109, 0
  v_mov_b32 v110, 0
  v_mov_b32 v111, 0
  v_mov_b32 v112, 0
  v_mov_b32 v113, 0
  v_mov_b32 v114, 0
  v_mov_b32 v115, 0
  v_mov_b32 v116, 0
  v_mov_b32 v117, 0
  v_mov_b32 v118, 0
  v_mov_b32 v119, 0
  v_mov_b32 v30, 0x3db504f3
  v_mov_b32 v31, 0x3db504f3
  v_mov_b32 v29, s80
  v_mov_b32 v120, 8768
  v_mov_b32 v121, 1
  s_mov_b32 exec_lo, 0x1
  s_mov_b32 exec_hi, 0x0
  ds_add_u32 v120, v121 offset:8
  s_mov_b64 exec, -1
  v_mov_b32 v123, 8768
Lw_1:
  ds_read_b32 v122, v123 offset:12
  s_add_u32 s60, s60, 1
  s_waitcnt lgkmcnt(0)
  v_readfirstlane_b32 s72, v122
  s_nop 0
  s_cmp_ge_u32 s72, 4
  s_cbranch_scc1 Lwd_2
  s_cmp_lt_u32 s60, 400000
  s_cbranch_scc1 Lw_1
Lwd_2:
  ds_read_b128 v[76:79], v9
  s_branch L_att
L_loop:
  s_cmp_eq_u32 s3, 6
  s_cbranch_scc0 L_nsub
  s_cmp_eq_u32 s58, 0
  s_cbranch_scc0 L_B1
  s_mov_b32 s20, s50
  s_mov_b32 s21, s51
  s_mov_b32 s22, 0x500
  s_mov_b32 s23, 0x20000
  v_lshlrev_b32 v104, 4, v0
  v_mov_b32 v76, 0
  v_mov_b32 v77, 0
  v_mov_b32 v78, 0
  v_mov_b32 v79, 0
  s_lshl_b32 s63, s5, 6
  v_and_b32 v108, 3, v0
  v_lshlrev_b32 v105, 3, v108
  v_sub_u32 v108, v104, v105
  s_mov_b32 exec_lo, 0x0
  s_mov_b32 exec_hi, 0xf
  buffer_load_dwordx2 v[76:77], v105, s[20:23], s63 offen
  buffer_load_dwordx2 v[78:79], v105, s[20:23], s63 offen offset:32
  s_mov_b64 exec, -1
  v_and_b32 v106, 15, v0
  v_mov_b32 v100, 0x3f80
  v_mov_b32 v101, 0x3f800000
  v_cmp_eq_u32 vcc, 0, v106
  s_nop 1
  v_cndmask_b32 v96, 0, v100, vcc
  v_cmp_eq_u32 vcc, 1, v106
  s_nop 1
  v_cndmask_b32 v96, v96, v101, vcc
  v_cmp_eq_u32 vcc, 2, v106
  s_nop 1
  v_cndmask_b32 v97, 0, v100, vcc
  v_cmp_eq_u32 vcc, 3, v106
  s_nop 1
  v_cndmask_b32 v97, v97, v101, vcc
  v_cmp_eq_u32 vcc, 4, v106
  s_nop 1
  v_cndmask_b32 v98, 0, v100, vcc
  v_cmp_eq_u32 vcc, 5, v106
  s_nop 1
  v_cndmask_b32 v98, v98, v101, vcc
  v_cmp_eq_u32 vcc, 6, v106
  s_nop 1
  v_cndmask_b32 v99, 0, v100, vcc
  v_cmp_eq_u32 vcc, 7, v106
  s_nop 1
  v_cndmask_b32 v99, v99, v101, vcc
  v_and_b32 v107, 0x3c0, v104
  v_add_u32 v107, v107, v104
  v_mov_b32 v105, 0x40000000
  v_cmp_gt_u32 vcc, 24, v0
  s_nop 1
  v_cndmask_b32 v105, v105, v107, vcc
  v_lshlrev_b32 v106, 3, v106
  v_lshrrev_b32 v100, 4, v0
  v_lshl_add_u32 v106, v100, 5, v106
  v_add_u32 v106, s63, v106
  s_and_b32 s62, s5, 15
  s_mul_i32 s62, s62, 512
  s_lshr_b32 s61, s5, 4
  s_lshl_b32 s61, s61, 14
  s_add_u32 s61, s61, s62
  s_add_u32 s72, s7, s78
  s_add_u32 s61, s61, s72
  s_add_u32 s61, s61, 0xfffb0000
  s_mov_b32 exec_lo, 0xffffffff
  s_mov_b32 exec_hi, 0x0
  buffer_load_dwordx2 v[76:77], v108, s[16:19], s61 offen sc1
  buffer_load_dwordx2 v[78:79], v108, s[16:19], s61 offen offset:32 sc1
Lp_3:
  s_add_u32 s60, s60, 1
  s_waitcnt vmcnt(0)
  v_max_u32 v126, v76, v78
  v_cmp_eq_u32 vcc, -1, v126
  s_cbranch_vccz Lpd_4
  s_mov_b64 exec, vcc
  buffer_load_dwordx2 v[76:77], v108, s[16:19], s61 offen sc1
  buffer_load_dwordx2 v[78:79], v108, s[16:19], s61 offen offset:32 sc1
  s_mov_b32 exec_lo, 0xffffffff
  s_mov_b32 exec_hi, 0x0
  s_cmp_lt_u32 s60, 400000
  s_cbranch_scc1 Lp_3
  s_waitcnt vmcnt(0)
Lpd_4:
  s_mov_b64 exec, -1
  v_mfma_f32_16x16x32_bf16 v[100:103], v[96:99], v[76:79], 0
  v_and_b32 v109, 10, v0
  v_mov_b32 v110, 0x3f80
  v_cmp_eq_u32 vcc, 0, v109
  s_nop 1
  v_cndmask_b32 v96, 0, v110, vcc
  v_cndmask_b32 v98, 0, v110, vcc
  v_cmp_eq_u32 vcc, 2, v109
  s_nop 1
  v_cndmask_b32 v97, 0, v110, vcc
  v_cndmask_b32 v99, 0, v110, vcc
  v_and_b32 v109, 1, v0
  v_bfe_u32 v110, v0, 2, 1
  v_lshl_add_u32 v109, v109, 1, v110
  v_mul_u32_u24 v109, 0x5555, v109
  s_and_b32 s61, s5, 1
  s_lshl_b32 s61, s61, 6
  s_lshr_b32 s62, s5, 1
  s_lshl_b32 s62, s62, 14
  s_add_u32 s61, s61, s62
  s_add_u32 s61, s61, s72
  s_add_u32 s61, s61, 0xfffd0000
  s_add_u32 s62, s61, 4096
  s_lshl_b32 s63, s4, 11
  s_add_u32 s63, s63, 114688
  v_lshlrev_b32 v125, 7, v0
  s_andn2_b32 s86, s61, 64
  s_add_u32 s86, s86, 7168
  s_nop 7
  s_setprio 3
  s_mov_b32 exec_lo, 0x1f
  s_mov_b32 exec_hi, 0x0
La_5:
  buffer_load_dword v126, v125, s[16:19], s86 offen sc1
  s_add_u32 s60, s60, 1
  s_waitcnt vmcnt(0)
  v_cmp_eq_u32 vcc, -1, v126
  s_cbranch_vccz Lad_6
  s_cmp_lt_u32 s60, 400000
  s_nop 1
  s_cbranch_scc1 La_5
Lad_6:
  s_mov_b64 exec, -1
  buffer_load_dwordx4 v[76:79], v107, s[16:19], s61 offen offset:0 sc1
  buffer_load_dwordx4 v[80:83], v107, s[16:19], s61 offen offset:2048 sc1
  buffer_load_dwordx4 v[84:87], v107, s[16:19], s62 offen offset:0 sc1
  buffer_load_dwordx4 v[88:91], v105, s[16:19], s62 offen offset:2048 sc1
Lp_7:
  s_add_u32 s60, s60, 1
  s_waitcnt vmcnt(0)
  v_max3_u32 v126, v76, v77, v78
  v_max3_u32 v126, v126, v79, v80
  v_max3_u32 v126, v126, v81, v82
  v_max3_u32 v126, v126, v83, v84
  v_max3_u32 v126, v126, v85, v86
  v_max3_u32 v126, v126, v87, v88
  v_max3_u32 v126, v126, v89, v90
  v_max_u32 v126, v126, v91
  v_cmp_eq_u32 vcc, -1, v126
  s_cbranch_vccz Lpd_8
  v_max3_u32 v127, v76, v77, v78
  v_max_u32 v127, v127, v79
  v_cmp_eq_u32 s[86:87], -1, v127
  v_max3_u32 v126, v80, v81, v82
  v_max_u32 v126, v126, v83
  v_cmp_eq_u32 s[88:89], -1, v126
  v_max3_u32 v127, v84, v85, v86
  v_max_u32 v127, v127, v87
  v_cmp_eq_u32 s[90:91], -1, v127
  v_max3_u32 v126, v88, v89, v90
  v_max_u32 v126, v126, v91
  v_cmp_eq_u32 s[92:93], -1, v126
  s_mov_b64 exec, s[86:87]
  buffer_load_dwordx4 v[76:79], v107, s[16:19], s61 offen offset:0 sc1
  s_mov_b64 exec, s[88:89]
  buffer_load_dwordx4 v[80:83], v107, s[16:19], s61 offen offset:2048 sc1
  s_mov_b64 exec, s[90:91]
  buffer_load_dwordx4 v[84:87], v107, s[16:19], s62 offen offset:0 sc1
  s_mov_b64 exec, s[92:93]
  buffer_load_dwordx4 v[88:91], v105, s[16:19], s62 offen offset:2048 sc1
  s_mov_b64 exec, -1
  s_cmp_lt_u32 s60, 400000
  s_cbranch_scc1 Lp_7
  s_waitcnt vmcnt(0)
Lpd_8:
  v_smfmac_f32_16x16x64_bf16 v[100:103], v[96:99], v[76:83], v109
  v_smfmac_f32_16x16x64_bf16 v[100:103], v[96:99], v[84:91], v109
  s_nop 7
  v_add_f32_dpp v100, v100, v100 row_ror:4 row_mask:0xf bank_mask:0xf
  v_add_f32_dpp v101, v101, v101 row_ror:4 row_mask:0xf bank_mask:0xf
  v_add_f32_dpp v102, v102, v102 row_ror:4 row_mask:0xf bank_mask:0xf
  v_add_f32_dpp v103, v103, v103 row_ror:4 row_mask:0xf bank_mask:0xf
  v_add_f32_dpp v100, v100, v100 row_ror:8 row_mask:0xf bank_mask:0xf
  v_add_f32_dpp v101, v101, v101 row_ror:8 row_mask:0xf bank_mask:0xf
  v_add_f32_dpp v102, v102, v102 row_ror:8 row_mask:0xf bank_mask:0xf
  v_add_f32_dpp v103, v103, v103 row_ror:8 row_mask:0xf bank_mask:0xf
  v_cvt_pk_bf16_f32 v100, v100, v101
  v_cvt_pk_bf16_f32 v101, v102, v103
  s_mov_b32 exec_lo, 0xf000f
  s_mov_b32 exec_hi, 0x0
  s_cmp_eq_u32 s6, 2
  s_cbranch_scc0 L_lead1
  buffer_store_dwordx2 v[100:101], v106, s[28:31], 0 offen
  s_mov_b64 exec, -1
  s_branch L_fin
L_lead1:
  v_min_u32 v100, 0xfffffffe, v100
  v_min_u32 v101, 0xfffffffe, v101
  s_cmp_eq_u32 s59, 0
  s_cbranch_scc1 Ls_9
  buffer_store_dwordx2 v[100:101], v106, s[16:19], s63 offen
  s_branch Lsd_10
Ls_9:
  buffer_store_dwordx2 v[100:101], v106, s[16:19], s63 offen sc1
Lsd_10:
  s_mov_b64 exec, -1
  s_setprio 0
  s_branch L_B1
L_nsub:
  s_cmp_ge_u32 s3, 5
  s_cbranch_scc1 L_B1
  s_lshl_b32 s61, s3, 13
  s_add_u32 s61, s61, 10240
  v_lshrrev_b32 v100, 5, v0
  v_lshlrev_b32 v100, 10, v100
  v_bfe_u32 v101, v0, 4, 1
  v_lshl_add_u32 v100, v101, 8, v100
  v_bfe_u32 v101, v0, 2, 1
  v_lshl_add_u32 v100, v101, 6, v100
  v_and_b32 v101, 3, v0
  v_lshl_add_u32 v100, v101, 3, v100
  v_bfe_u32 v101, v0, 3, 1
  v_lshl_add_u32 v100, v101, 9, v100
  v_xor_b32 v101, s73, v101
  v_and_b32 v101, 1, v101
  v_lshl_add_u32 v100, v101, 5, v100
  v_add_u32 v100, s61, v100
  ds_read_b64_tr_b16 v[28:29], v100 offset:0
  ds_read_b64_tr_b16 v[30:31], v100 offset:128
  ds_read_b64_tr_b16 v[32:33], v100 offset:2048
  ds_read_b64_tr_b16 v[34:35], v100 offset:2176
  ds_read_b64_tr_b16 v[36:37], v100 offset:4096
  ds_read_b64_tr_b16 v[38:39], v100 offset:4224
  ds_read_b64_tr_b16 v[40:41], v100 offset:6144
  ds_read_b64_tr_b16 v[42:43], v100 offset:6272
  v_mov_b32 v76, 0
  v_mov_b32 v77, 0
  v_mov_b32 v78, 0
  v_mov_b32 v79, 0
  v_mov_b32 v80, 0
  v_mov_b32 v81, 0
  v_mov_b32 v82, 0
  v_mov_b32 v83, 0
  v_mov_b32 v108, 0x3f803f80
  v_mov_b32 v109, 0x3f803f80
  v_mov_b32 v110, 0x3f803f80
  v_mov_b32 v111, 0x3f803f80
  s_lshl_b32 s63, s4, 11
  s_add_u32 s63, s63, 114688
  s_waitcnt lgkmcnt(0)
  s_mov_b32 exec_lo, 0x55555555
  s_mov_b32 exec_hi, 0x55555555
  buffer_load_dwordx4 v[108:111], v2, s[16:19], s63 offen sc1
Lp_11:
  s_add_u32 s60, s60, 1
  s_waitcnt vmcnt(0)
  v_max_u32 v126, v108, v110
  v_cmp_eq_u32 vcc, -1, v126
  s_cbranch_vccz Lpd_12
  s_mov_b64 exec, vcc
  buffer_load_dwordx4 v[108:111], v2, s[16:19], s63 offen sc1
  s_mov_b32 exec_lo, 0x55555555
  s_mov_b32 exec_hi, 0x55555555
  s_cmp_lt_u32 s60, 400000
  s_cbranch_scc1 Lp_11
  s_waitcnt vmcnt(0)
Lpd_12:
  s_mov_b64 exec, -1
  v_mfma_f32_16x16x32_bf16 v[84:87], v[108:111], v[108:111], 0
  v_smfmac_f32_16x16x64_bf16 v[76:79], v[108:111], v[28:35], v24
  v_smfmac_f32_16x16x64_bf16 v[80:83], v[108:111], v[36:43], v24
  ds_write_b64 v8, v[84:85]
  s_nop 2
  v_pk_add_f32 v[76:77], v[76:77], v[78:79]
  s_mov_b32 exec_lo, 0xffff0000
  s_mov_b32 exec_hi, 0
  s_nop 0
  v_pk_add_f32 v[76:77], v[80:81], v[82:83]
  s_mov_b32 exec_lo, -1
  ds_write_b64 v3, v[76:77] offset:0
  s_mov_b32 exec_hi, -1
  s_waitcnt lgkmcnt(0)
L_B1:
  v_mov_b32 v116, 0x3acccccd
  s_add_u32 s63, s101, s7
  s_sub_u32 s63, s63, 8448
  s_cmp_eq_u32 s3, 5
  s_cbranch_scc1 L_B15
  s_barrier
  v_mov_b32 v80, 0
  v_mov_b32 v81, 0
  v_mov_b32 v82, 0
  v_mov_b32 v83, 0
  v_mov_b32 v84, 0
  v_mov_b32 v85, 0
  v_mov_b32 v86, 0
  v_mov_b32 v87, 0
  v_mov_b32 v88, 0
  v_mov_b32 v89, 0
  v_mov_b32 v90, 0
  v_mov_b32 v91, 0
  v_mov_b32 v92, 0
  v_mov_b32 v93, 0
  v_mov_b32 v94, 0
  v_mov_b32 v95, 0
  v_mov_b32 v96, 0
  v_mov_b32 v97, 0
  v_mov_b32 v98, 0
  v_mov_b32 v99, 0
  v_mov_b32 v100, 0
  v_mov_b32 v101, 0
  v_mov_b32 v102, 0
  v_mov_b32 v103, 0
  v_mov_b32 v104, 0
  v_mov_b32 v105, 0
  v_mov_b32 v106, 0
  v_mov_b32 v107, 0
  v_mov_b32 v108, 0
  v_mov_b32 v109, 0
  v_mov_b32 v110, 0
  v_mov_b32 v111, 0
  v_mov_b32 v112, 0
  v_mov_b32 v113, 0
  v_mov_b32 v114, 0
  v_mov_b32 v115, 0
  v_mov_b32 v116, 0
  v_mov_b32 v117, 0
  v_mov_b32 v118, 0
  v_mov_b32 v119, 0
  v_mov_b32 v30, 0x3db504f3
  v_mov_b32 v31, 0x3db504f3
  v_mov_b32 v29, s80
  s_barrier
  s_branch L_B2
L_B15:
  s_setprio 3
  v_mov_b32 v80, 0
  v_mov_b32 v81, 0
  v_mov_b32 v82, 0
  v_mov_b32 v83, 0
  v_mov_b32 v84, 0
  v_mov_b32 v85, 0
  v_mov_b32 v86, 0
  v_mov_b32 v87, 0
  v_mov_b32 v88, 0
  v_mov_b32 v89, 0
  v_mov_b32 v90, 0
  v_mov_b32 v91, 0
  v_mov_b32 v92, 0
  v_mov_b32 v93, 0
  v_mov_b32 v94, 0
  v_mov_b32 v95, 0
  v_mov_b32 v96, 0
  v_mov_b32 v97, 0
  v_mov_b32 v98, 0
  v_mov_b32 v99, 0
  v_mov_b32 v100, 0
  v_mov_b32 v101, 0
  v_mov_b32 v102, 0
  v_mov_b32 v103, 0
  v_mov_b32 v104, 0
  v_mov_b32 v105, 0
  v_mov_b32 v106, 0
  v_mov_b32 v107, 0
  v_mov_b32 v30, 0x3db504f3
  v_mov_b32 v31, 0x3db504f3
  v_mov_b32 v29, s80
  s_barrier
  ds_read_b64 v[60:61], v4 offset:512
  ds_read_b64 v[62:63], v4 offset:1056
  ds_read_b64 v[64:65], v4 offset:1600
  ds_read_b64 v[66:67], v4 offset:2144
  ds_read_b64 v[68:69], v4 offset:2688
  ds_read_b128 v[32:35], v3 offset:0
  ds_read_b128 v[36:39], v3 offset:544
  ds_read_b128 v[40:43], v3 offset:1088
  ds_read_b128 v[120:123], v3 offset:1632
  ds_read_b128 v[124:127], v3 offset:2176
  s_waitcnt lgkmcnt(5)
  v_pk_add_f32 v[60:61], v[60:61], v[62:63]
  v_pk_add_f32 v[64:65], v[64:65], v[66:67]
  v_pk_add_f32 v[60:61], v[60:61], v[68:69]
  v_pk_add_f32 v[60:61], v[60:61], v[64:65]
  s_nop 1
  v_add_f32_dpp v61, v61, v61 quad_perm:[1,0,3,2] row_mask:0xf bank_mask:0xf
  v_add_f32_dpp v60, v60, v60 quad_perm:[1,0,3,2] row_mask:0xf bank_mask:0xf
  s_nop 0
  v_add_f32_dpp v61, v61, v61 quad_perm:[2,3,0,1] row_mask:0xf bank_mask:0xf
  v_add_f32_dpp v60, v60, v60 quad_perm:[2,3,0,1] row_mask:0xf bank_mask:0xf
  v_mul_f32 v109, v61, v116
  v_mul_f32 v110, v60, v116
  v_fma_f32 v110, -v109, v109, v110
  v_max_f32 v110, 0, v110
  v_cvt_pk_bf16_f32 v115, v109, v110
  v_and_b32 v114, 0xffff0000, v115
  v_lshlrev_b32 v111, 16, v115
  v_add_f32 v114, 0x3727c5ac, v114
  v_cvt_pk_bf16_f32 v114, v114, v114
  v_and_b32 v114, 0xffff0000, v114
  v_sqrt_f32 v114, v114
  s_nop 0
  v_cvt_pk_bf16_f32 v114, v114, v114
  v_and_b32 v112, 0xffff0000, v114
  v_rcp_f32 v113, v112
  s_waitcnt lgkmcnt(0)
  v_pk_add_f32 v[32:33], v[32:33], v[34:35]
  v_pk_add_f32 v[36:37], v[36:37], v[38:39]
  v_pk_add_f32 v[40:41], v[40:41], v[42:43]
  v_pk_add_f32 v[120:121], v[120:121], v[122:123]
  v_pk_add_f32 v[124:125], v[124:125], v[126:127]
  v_pk_add_f32 v[32:33], v[32:33], v[36:37]
  v_pk_add_f32 v[40:41], v[40:41], v[120:121]
  v_pk_add_f32 v[32:33], v[32:33], v[124:125]
  v_pk_add_f32 v[32:33], v[32:33], v[40:41]
  v_fma_f32 v114, -v111, v33, v32
  s_nop 1
  v_mul_f32_dpp v115, v114, v113 quad_perm:[0,0,2,2] row_mask:0xf bank_mask:0xf
  v_mul_f32_dpp v114, v114, v113 quad_perm:[1,1,3,3] row_mask:0xf bank_mask:0xf
  v_cvt_pk_bf16_f32 v114, v115, v114
  v_min_u32 v114, 0xfffffffe, v114
  s_cmp_eq_u32 s59, 0
  s_cbranch_scc1 Ls_13
  buffer_store_dword v114, v2, s[16:19], s7 offen
  s_branch Lsd_14
Ls_13:
  buffer_store_dword v114, v2, s[16:19], s7 offen sc1
Lsd_14:
  s_setprio 0
  s_barrier
  buffer_load_ushort v72, v16, s[16:19], 0 offen sc1
  v_mov_b32 v108, 0
  v_mov_b32 v109, 0
  v_mov_b32 v110, 0
  v_mov_b32 v111, 0
  v_mov_b32 v112, 0
  v_mov_b32 v113, 0
  v_mov_b32 v114, 0
  v_mov_b32 v115, 0
  v_mov_b32 v116, 0
  v_mov_b32 v117, 0
  v_mov_b32 v118, 0
  v_mov_b32 v119, 0
L_B2:
  buffer_load_dwordx4 v[76:79], v9, s[16:19], s63 offen sc1
Lp_15:
  s_add_u32 s60, s60, 1
  s_waitcnt vmcnt(0)
  v_max3_u32 v126, v76, v77, v78
  v_max_u32 v126, v126, v79
  v_cmp_eq_u32 vcc, -1, v126
  s_cbranch_vccz Lpd_16
  s_mov_b64 exec, vcc
  buffer_load_dwordx4 v[76:79], v9, s[16:19], s63 offen sc1
  s_mov_b64 exec, -1
  s_cmp_lt_u32 s60, 400000
  s_cbranch_scc1 Lp_15
  s_waitcnt vmcnt(0)
Lpd_16:
L_att:
  s_waitcnt vmcnt(16) lgkmcnt(0)
  v_smfmac_f32_16x16x64_bf16 v[80:83], v[76:79], v[128:135], v24
  v_smfmac_f32_16x16x64_bf16 v[84:87], v[76:79], v[136:143], v24
  v_smfmac_f32_16x16x64_bf16 v[88:91], v[76:79], v[144:151], v24
  v_add_f32_dpp v120, v80, v82 quad_perm:[0,1,2,3] row_mask:0x1 bank_mask:0xf
  v_add_f32_dpp v121, v81, v83 quad_perm:[0,1,2,3] row_mask:0x1 bank_mask:0xf
  v_smfmac_f32_16x16x64_bf16 v[92:95], v[76:79], v[152:159], v24
  v_add_f32_dpp v122, v84, v86 quad_perm:[0,1,2,3] row_mask:0x1 bank_mask:0xf
  v_add_f32_dpp v123, v85, v87 quad_perm:[0,1,2,3] row_mask:0x1 bank_mask:0xf
  v_smfmac_f32_16x16x64_bf16 v[96:99], v[76:79], v[160:167], v24
  v_add_f32_dpp v120, v88, v90 quad_perm:[0,1,2,3] row_mask:0x2 bank_mask:0xf
  v_add_f32_dpp v121, v89, v91 quad_perm:[0,1,2,3] row_mask:0x2 bank_mask:0xf
  v_smfmac_f32_16x16x64_bf16 v[100:103], v[76:79], v[168:175], v24
  v_add_f32_dpp v122, v92, v94 quad_perm:[0,1,2,3] row_mask:0x2 bank_mask:0xf
  v_add_f32_dpp v123, v93, v95 quad_perm:[0,1,2,3] row_mask:0x2 bank_mask:0xf
  v_smfmac_f32_16x16x64_bf16 v[104:107], v[76:79], v[176:183], v24
  v_add_f32_dpp v120, v96, v98 quad_perm:[0,1,2,3] row_mask:0x4 bank_mask:0xf
  v_add_f32_dpp v121, v97, v99 quad_perm:[0,1,2,3] row_mask:0x4 bank_mask:0xf
  v_smfmac_f32_16x16x64_bf16 v[108:111], v[76:79], v[184:191], v24
  v_add_f32_dpp v122, v100, v102 quad_perm:[0,1,2,3] row_mask:0x4 bank_mask:0xf
  v_add_f32_dpp v123, v101, v103 quad_perm:[0,1,2,3] row_mask:0x4 bank_mask:0xf
  s_nop 1
  v_add_f32_dpp v120, v104, v106 quad_perm:[0,1,2,3] row_mask:0x8 bank_mask:0xf
  v_add_f32_dpp v121, v105, v107 quad_perm:[0,1,2,3] row_mask:0x8 bank_mask:0xf
  s_nop 1
  v_add_f32_dpp v122, v108, v110 quad_perm:[0,1,2,3] row_mask:0x8 bank_mask:0xf
  v_add_f32_dpp v123, v109, v111 quad_perm:[0,1,2,3] row_mask:0x8 bank_mask:0xf
  v_mov_b32_dpp v124, v120 quad_perm:[0,0,2,2] row_mask:0xf bank_mask:0xf
  v_mov_b32_dpp v125, v122 quad_perm:[0,0,2,2] row_mask:0xf bank_mask:0xf
  s_nop 0
  v_add_f32_dpp v124, v121, v124 quad_perm:[1,1,3,3] row_mask:0xf bank_mask:0xf
  v_add_f32_dpp v125, v123, v125 quad_perm:[1,1,3,3] row_mask:0xf bank_mask:0xf
  v_cvt_pk_bf16_f32 v28, v124, v125
  v_lshlrev_b32 v124, 16, v28
  v_and_b32 v125, 0xffff0000, v28
  v_pk_mul_f32 v[124:125], v[124:125], v[30:31]
  v_cvt_pk_bf16_f32 v28, v124, v125
  v_lshlrev_b32 v124, 16, v28
  v_and_b32 v125, 0xffff0000, v28
  v_max_f32 v32, v124, v125
  s_nop 1
  v_max_f32_dpp v32, v32, v32 quad_perm:[2,3,0,1] row_mask:0xf bank_mask:0xf
  s_nop 1
  v_max_f32_dpp v32, v32, v32 row_ror:4 row_mask:0xf bank_mask:0xf
  s_nop 1
  v_max_f32_dpp v32, v32, v32 row_ror:8 row_mask:0xf bank_mask:0xf
  s_nop 1
  v_max_f32_dpp v32, v32, v32 row_bcast:15 row_mask:0xa bank_mask:0xf
  s_nop 1
  v_max_f32_dpp v32, v32, v32 row_bcast:31 row_mask:0xc bank_mask:0xf
  s_nop 0
  v_readlane_b32 s81, v32, 63
  s_nop 1
  v_mul_f32 v34, s81, v29
  v_fma_f32 v124, v124, v29, -v34
  v_fma_f32 v125, v125, v29, -v34
  v_exp_f32 v124, v124
  v_exp_f32 v125, v125
  s_cmp_eq_u32 s6, 0
  s_cbranch_scc0 L_PV
  s_cmp_eq_u32 s100, 0
  s_cbranch_scc1 L_PVe
  s_lshl_b32 s62, s3, 13
  s_add_u32 s62, s62, 51200
  s_mov_b32 s61, s82
  s_mov_b32 m0, s62
  s_add_u32 s62, s62, 4096
  s_cmp_gt_u32 s84, 0
  s_cselect_b32 s63, s61, 0x40000000
  buffer_load_dwordx4 v17, s[24:27], s63 offen offset:0  lds
  s_add_u32 s61, s61, s83
  s_sub_u32 s61, s61, 1024
  s_cmp_gt_u32 s84, 1
  s_cselect_b32 s63, s61, 0x40000000
  buffer_load_dwordx4 v17, s[24:27], s63 offen offset:1024  lds
  s_add_u32 s61, s61, s83
  s_sub_u32 s61, s61, 1024
  s_cmp_gt_u32 s84, 2
  s_cselect_b32 s63, s61, 0x40000000
  buffer_load_dwordx4 v17, s[24:27], s63 offen offset:2048  lds
  s_add_u32 s61, s61, s83
  s_sub_u32 s61, s61, 1024
  s_cmp_gt_u32 s84, 3
  s_cselect_b32 s63, s61, 0x40000000
  buffer_load_dwordx4 v17, s[24:27], s63 offen offset:3072  lds
  s_add_u32 s61, s61, s83
  s_add_u32 s61, s61, 3072
  s_mov_b32 m0, s62
  s_cmp_gt_u32 s84, 4
  s_cselect_b32 s63, s61, 0x40000000
  buffer_load_dwordx4 v17, s[24:27], s63 offen offset:0  lds
  s_add_u32 s61, s61, s83
  s_sub_u32 s61, s61, 1024
  s_cmp_gt_u32 s84, 5
  s_cselect_b32 s63, s61, 0x40000000
  buffer_load_dwordx4 v17, s[24:27], s63 offen offset:1024  lds
  s_add_u32 s61, s61, s83
  s_sub_u32 s61, s61, 1024
  s_cmp_gt_u32 s84, 6
  s_cselect_b32 s63, s61, 0x40000000
  buffer_load_dwordx4 v17, s[24:27], s63 offen offset:2048  lds
  s_add_u32 s61, s61, s83
  s_sub_u32 s61, s61, 1024
  s_cmp_gt_u32 s84, 7
  s_cselect_b32 s63, s61, 0x40000000
  buffer_load_dwordx4 v17, s[24:27], s63 offen offset:3072  lds
  s_branch L_PV
L_PVe:
  s_cmp_eq_u32 s3, 7
  s_cbranch_scc0 L_PVe2
  s_mov_b32 s20, s54
  s_mov_b32 s21, s55
  s_mov_b32 s22, 0x100
  s_mov_b32 s23, 0x20000
  v_lshlrev_b32 v78, 5, v0
  s_mov_b32 exec_lo, 0xff
  s_mov_b32 exec_hi, 0x0
  buffer_load_dwordx2 v[76:77], v78, s[20:23], 0 offen offset:0
  s_mov_b64 exec, -1
  s_waitcnt vmcnt(1)
  s_branch L_PV
L_PVe2:
  s_waitcnt vmcnt(0)
L_PV:
  v_cvt_pk_bf16_f32 v35, v124, v125
  v_add_f32 v33, v124, v125
  s_nop 0
  v_mov_b32_dpp v34, v35 row_half_mirror row_mask:0xf bank_mask:0xf
  v_and_b32_dpp v92, v35, v20 quad_perm:[0,0,0,0] row_mask:0xf bank_mask:0xf
  v_and_b32_dpp v94, v35, v22 quad_perm:[0,0,0,0] row_mask:0xf bank_mask:0xf
  v_and_b32_dpp v93, v34, v21 quad_perm:[3,3,3,3] row_mask:0xf bank_mask:0xf
  v_and_b32_dpp v95, v34, v23 quad_perm:[3,3,3,3] row_mask:0xf bank_mask:0xf
  v_and_b32_dpp v96, v35, v20 quad_perm:[2,2,2,2] row_mask:0xf bank_mask:0xf
  v_and_b32_dpp v98, v35, v22 quad_perm:[2,2,2,2] row_mask:0xf bank_mask:0xf
  v_and_b32_dpp v97, v34, v21 quad_perm:[1,1,1,1] row_mask:0xf bank_mask:0xf
  v_and_b32_dpp v99, v34, v23 quad_perm:[1,1,1,1] row_mask:0xf bank_mask:0xf
  s_waitcnt vmcnt(22)
  v_smfmac_f32_16x16x64_bf16 v[112:115], v[92:95], v[192:199], v24 abid:1
  v_and_b32_dpp v101, v35, v21 quad_perm:[0,0,0,0] row_mask:0xf bank_mask:0xf
  v_and_b32_dpp v103, v35, v23 quad_perm:[0,0,0,0] row_mask:0xf bank_mask:0xf
  v_and_b32_dpp v100, v34, v20 quad_perm:[3,3,3,3] row_mask:0xf bank_mask:0xf
  v_and_b32_dpp v102, v34, v22 quad_perm:[3,3,3,3] row_mask:0xf bank_mask:0xf
  s_waitcnt vmcnt(20)
  v_smfmac_f32_16x16x64_bf16 v[116:119], v[92:95], v[200:207], v24 abid:1
  v_add_f32_dpp v33, v33, v33 quad_perm:[2,3,0,1] row_mask:0xf bank_mask:0xf
  s_waitcnt vmcnt(18)
  v_smfmac_f32_16x16x64_bf16 v[112:115], v[96:99], v[208:215], v24 abid:1
  v_and_b32_dpp v105, v35, v21 quad_perm:[2,2,2,2] row_mask:0xf bank_mask:0xf
  v_and_b32_dpp v107, v35, v23 quad_perm:[2,2,2,2] row_mask:0xf bank_mask:0xf
  v_and_b32_dpp v104, v34, v20 quad_perm:[1,1,1,1] row_mask:0xf bank_mask:0xf
  v_and_b32_dpp v106, v34, v22 quad_perm:[1,1,1,1] row_mask:0xf bank_mask:0xf
  s_waitcnt vmcnt(16)
  v_smfmac_f32_16x16x64_bf16 v[116:119], v[96:99], v[216:223], v24 abid:1
  v_add_f32_dpp v33, v33, v33 row_ror:4 row_mask:0xf bank_mask:0xf
  s_waitcnt vmcnt(14)
  v_smfmac_f32_16x16x64_bf16 v[112:115], v[100:103], v[224:231], v24 abid:1
  v_add_f32_dpp v33, v33, v33 row_ror:8 row_mask:0xf bank_mask:0xf
  s_nop 0
  s_nop 0
  v_add_f32_dpp v33, v33, v33 row_bcast:15 row_mask:0xa bank_mask:0xf
  s_waitcnt vmcnt(12)
  v_smfmac_f32_16x16x64_bf16 v[116:119], v[100:103], v[232:239], v24 abid:1
  v_add_f32_dpp v33, v33, v33 row_bcast:31 row_mask:0xc bank_mask:0xf
  s_nop 0
  ds_write_b64 v11, v[32:33]
  s_waitcnt vmcnt(10)
  v_smfmac_f32_16x16x64_bf16 v[112:115], v[104:107], v[240:247], v24 abid:1
  s_waitcnt vmcnt(8)
  v_smfmac_f32_16x16x64_bf16 v[116:119], v[104:107], v[248:255], v24 abid:1
  s_mov_b32 exec_lo, 0xff00ff
  s_mov_b32 exec_hi, 0xff00ff00
  s_nop 1
  ds_write_b128 v10, v[112:115]
  s_nop 2
  ds_write_b128 v10, v[116:119] offset:256
  s_mov_b64 exec, -1
  s_cmp_eq_u32 s6, 0
  s_cbranch_scc0 L_B3
  s_setprio 0
  s_cmp_eq_u32 s100, 0
  s_cbranch_scc0 L_B3
  s_cmp_eq_u32 s3, 7
  s_cbranch_scc0 L_erd
  s_setprio 3
  s_mov_b32 s20, s54
  s_mov_b32 s21, s55
  s_mov_b32 s22, 0x100
  s_mov_b32 s23, 0x20000
  s_mov_b32 exec_lo, 0xff
  s_mov_b32 exec_hi, 0x0
L_sync:
  s_add_u32 s60, s60, 4
  s_waitcnt vmcnt(0)
  v_and_b32 v79, 0x200000, v77
  v_cmp_eq_u32 vcc, 0, v79
  s_cbranch_vccz L_syncd
  buffer_load_dwordx2 v[76:77], v78, s[20:23], 0 offen offset:0 sc1
  s_cmp_lt_u32 s60, 400000
  s_nop 0
  s_cbranch_scc1 L_sync
  s_waitcnt vmcnt(0)
L_syncd:
  v_lshrrev_b32 v79, 24, v77
  v_readlane_b32 s64, v76, s4
  v_readlane_b32 s65, v77, s4
  v_add_u32_dpp v79, v79, v79 quad_perm:[1,0,3,2] row_mask:0xf bank_mask:0xf
  s_nop 1
  v_add_u32_dpp v79, v79, v79 quad_perm:[2,3,0,1] row_mask:0xf bank_mask:0xf
  s_nop 1
  v_add_u32_dpp v79, v79, v79 row_half_mirror row_mask:0xf bank_mask:0xf
  s_mul_i32 s61, s74, 6
  s_lshr_b64 s[64:65], s[64:65], s61
  s_and_b32 s64, s64, 63
  s_cmp_eq_u32 s64, 32
  s_cselect_b32 s62, 1, 0
  s_cmp_lt_u32 s74, 8
  s_cselect_b32 s62, s62, 0
  v_readfirstlane_b32 s61, v79
  s_mov_b64 exec, -1
  s_cmp_gt_u32 s61, 16
  s_cselect_b32 s61, 1, 0
  s_lshr_b32 s63, s74, 2
  s_xor_b32 s61, s61, s63
  s_and_b32 s61, s61, 1
  s_lshl_b32 s61, s61, 13
  s_or_b32 s61, s61, s62
  v_mov_b32 v76, s61
  v_mov_b32 v77, 8768
  ds_write_b32 v77, v76
  s_setprio 0
L_erd:
  s_cmp_eq_u32 s58, 0
  s_cbranch_scc1 L_erd2
  s_waitcnt lgkmcnt(0)
  s_cmp_eq_u32 s58, 3
  s_cbranch_scc1 L_erd3
  v_mov_b32 v123, 8768
Lw_17:
  ds_read_b32 v122, v123 offset:8
  s_add_u32 s60, s60, 1
  s_waitcnt lgkmcnt(0)
  v_readfirstlane_b32 s72, v122
  s_nop 0
  s_cmp_ge_u32 s72, 8
  s_cbranch_scc1 Lwd_18
  s_cmp_lt_u32 s60, 400000
  s_cbranch_scc1 Lw_17
Lwd_18:
  s_mul_i32 s61, s3, 5
  s_mul_i32 s72, s75, 40960
  v_lshrrev_b32 v76, 3, v0
  v_mul_u32_u24 v78, 1280, v76
  v_and_b32 v77, 7, v0
  v_lshlrev_b32 v77, 4, v77
  v_bfe_u32 v76, v0, 4, 1
  v_lshlrev_b32 v76, 5, v76
  v_xor_b32 v77, v77, v76
  s_and_b32 s62, s61, 1
  s_lshl_b32 s62, s62, 6
  v_xor_b32 v77, s62, v77
  v_xor_b32 v76, 64, v77
  v_add_u32 v79, v78, v76
  v_add_u32 v78, v78, v77
  s_mov_b32 s20, s48
  s_mov_b32 s21, s49
  s_mov_b32 s22, 0x21c000
  s_mov_b32 s23, 0x20000
  s_lshl_b32 s62, s61, 10
  s_add_u32 m0, s62, 92160
  s_and_b32 s62, s61, 3
  s_mul_i32 s62, s62, 10240
  s_lshr_b32 s63, s61, 2
  s_lshl_b32 s63, s63, 7
  s_add_u32 s62, s62, s63
  s_add_u32 s62, s62, s72
  buffer_load_dwordx4 v78, s[20:23], s62 offen  lds
  s_add_u32 s61, s61, 1
  s_lshl_b32 s62, s61, 10
  s_add_u32 m0, s62, 92160
  s_and_b32 s62, s61, 3
  s_mul_i32 s62, s62, 10240
  s_lshr_b32 s63, s61, 2
  s_lshl_b32 s63, s63, 7
  s_add_u32 s62, s62, s63
  s_add_u32 s62, s62, s72
  buffer_load_dwordx4 v79, s[20:23], s62 offen  lds
  s_add_u32 s61, s61, 1
  s_lshl_b32 s62, s61, 10
  s_add_u32 m0, s62, 92160
  s_and_b32 s62, s61, 3
  s_mul_i32 s62, s62, 10240
  s_lshr_b32 s63, s61, 2
  s_lshl_b32 s63, s63, 7
  s_add_u32 s62, s62, s63
  s_add_u32 s62, s62, s72
  buffer_load_dwordx4 v78, s[20:23], s62 offen  lds
  s_add_u32 s61, s61, 1
  s_lshl_b32 s62, s61, 10
  s_add_u32 m0, s62, 92160
  s_and_b32 s62, s61, 3
  s_mul_i32 s62, s62, 10240
  s_lshr_b32 s63, s61, 2
  s_lshl_b32 s63, s63, 7
  s_add_u32 s62, s62, s63
  s_add_u32 s62, s62, s72
  buffer_load_dwordx4 v79, s[20:23], s62 offen  lds
  s_add_u32 s61, s61, 1
  s_lshl_b32 s62, s61, 10
  s_add_u32 m0, s62, 92160
  s_and_b32 s62, s61, 3
  s_mul_i32 s62, s62, 10240
  s_lshr_b32 s63, s61, 2
  s_lshl_b32 s63, s63, 7
  s_add_u32 s62, s62, s63
  s_add_u32 s62, s62, s72
  buffer_load_dwordx4 v78, s[20:23], s62 offen  lds
  s_branch L_B3
L_erd3:
  v_mov_b32 v123, 8768
Lw_19:
  ds_read_b32 v122, v123 offset:8
  s_add_u32 s60, s60, 1
  s_waitcnt lgkmcnt(0)
  v_readfirstlane_b32 s72, v122
  s_nop 0
  s_cmp_ge_u32 s72, 8
  s_cbranch_scc1 Lwd_20
  s_cmp_lt_u32 s60, 400000
  s_cbranch_scc1 Lw_19
Lwd_20:
  s_sub_u32 s61, 31, s5
  s_min_u32 s61, s61, 5
  s_mul_i32 s62, s3, 5
  s_cmp_lt_u32 s61, 5
  s_cselect_b32 s62, s62, 99
  s_add_u32 s61, s61, s62
  s_mul_i32 s62, s4, 7
  s_min_u32 s62, s62, 48
  s_mov_b32 s20, s44
  s_mov_b32 s21, s45
  s_mov_b32 s22, 0x21c000
  s_mov_b32 s23, 0x20000
  v_lshrrev_b32 v125, 2, v0
  v_mul_u32_u24 v125, 3456, v125
  v_and_b32 v126, 3, v0
  v_lshl_add_u32 v125, v126, 7, v125
  s_mul_i32 s61, s61, 55296
  s_lshr_b32 s62, s62, 1
  s_lshl_b32 s62, s62, 7
  s_add_u32 s61, s61, s62
  v_add_u32 v125, s61, v125
  buffer_load_dword v126, v125, s[20:23], 0 offen
L_ps4:
  s_branch L_B3
L_erd2:
  v_mov_b32 v123, 8768
Lw_21:
  ds_read_b32 v122, v123 offset:8
  s_add_u32 s60, s60, 1
  s_waitcnt lgkmcnt(0)
  v_readfirstlane_b32 s72, v122
  s_nop 0
  s_cmp_ge_u32 s72, 4
  s_cbranch_scc1 Lwd_22
  s_cmp_lt_u32 s60, 400000
  s_cbranch_scc1 Lw_21
Lwd_22:
  s_lshl_b32 s62, s3, 13
  s_add_u32 s62, s62, 51200
  s_mov_b32 s61, s82
  s_mov_b32 m0, s62
  s_add_u32 s62, s62, 4096
  s_cmp_gt_u32 s84, 0
  s_cselect_b32 s63, s61, 0x40000000
  buffer_load_dwordx4 v17, s[24:27], s63 offen offset:0  lds
  s_add_u32 s61, s61, s83
  s_sub_u32 s61, s61, 1024
  s_cmp_gt_u32 s84, 1
  s_cselect_b32 s63, s61, 0x40000000
  buffer_load_dwordx4 v17, s[24:27], s63 offen offset:1024  lds
  s_add_u32 s61, s61, s83
  s_sub_u32 s61, s61, 1024
  s_cmp_gt_u32 s84, 2
  s_cselect_b32 s63, s61, 0x40000000
  buffer_load_dwordx4 v17, s[24:27], s63 offen offset:2048  lds
  s_add_u32 s61, s61, s83
  s_sub_u32 s61, s61, 1024
  s_cmp_gt_u32 s84, 3
  s_cselect_b32 s63, s61, 0x40000000
  buffer_load_dwordx4 v17, s[24:27], s63 offen offset:3072  lds
  s_add_u32 s61, s61, s83
  s_add_u32 s61, s61, 3072
  s_mov_b32 m0, s62
  s_cmp_gt_u32 s84, 4
  s_cselect_b32 s63, s61, 0x40000000
  buffer_load_dwordx4 v17, s[24:27], s63 offen offset:0  lds
  s_add_u32 s61, s61, s83
  s_sub_u32 s61, s61, 1024
  s_cmp_gt_u32 s84, 5
  s_cselect_b32 s63, s61, 0x40000000
  buffer_load_dwordx4 v17, s[24:27], s63 offen offset:1024  lds
  s_add_u32 s61, s61, s83
  s_sub_u32 s61, s61, 1024
  s_cmp_gt_u32 s84, 6
  s_cselect_b32 s63, s61, 0x40000000
  buffer_load_dwordx4 v17, s[24:27], s63 offen offset:2048  lds
  s_add_u32 s61, s61, s83
  s_sub_u32 s61, s61, 1024
  s_cmp_gt_u32 s84, 7
  s_cselect_b32 s63, s61, 0x40000000
  buffer_load_dwordx4 v17, s[24:27], s63 offen offset:3072  lds
L_B3:
  s_waitcnt lgkmcnt(0)
  v_mov_b32 v114, 8768
  s_barrier
  ds_read_b64 v[114:115], v114
  s_cmp_eq_u32 s3, 7
  s_cbranch_scc1 L_comb
  s_waitcnt lgkmcnt(0)
  v_readfirstlane_b32 s61, v114
  s_nop 0
  s_and_b32 s59, s61, 1
  s_and_b32 s78, s61, 8192
  s_branch L_role
L_comb:
  s_setprio 3
  ds_read_b64 v[108:109], v2
  ds_read2st64_b64 v[76:79], v1 offset0:0 offset1:1
  ds_read2st64_b64 v[80:83], v1 offset0:2 offset1:3
  ds_read2st64_b64 v[84:87], v1 offset0:4 offset1:5
  ds_read2st64_b64 v[88:91], v1 offset0:6 offset1:7
  ds_read2st64_b64 v[92:95], v1 offset0:8 offset1:9
  ds_read2st64_b64 v[96:99], v1 offset0:10 offset1:11
  ds_read2st64_b64 v[100:103], v1 offset0:12 offset1:13
  ds_read2st64_b64 v[104:107], v1 offset0:14 offset1:15
  v_mov_b32 v113, s80
  s_waitcnt lgkmcnt(8)
  v_readfirstlane_b32 s61, v114
  v_max_f32_dpp v110, v108, v108 quad_perm:[1,0,3,2] row_mask:0xf bank_mask:0xf
  s_nop 1
  v_max_f32_dpp v110, v110, v110 quad_perm:[2,3,0,1] row_mask:0xf bank_mask:0xf
  s_nop 1
  v_max_f32_dpp v110, v110, v110 row_half_mirror row_mask:0xf bank_mask:0xf
  v_sub_f32 v112, v108, v110
  v_mul_f32 v112, v112, v113
  v_exp_f32 v112, v112
  s_and_b32 s59, s61, 1
  s_and_b32 s78, s61, 8192
  s_waitcnt lgkmcnt(0)
  v_readlane_b32 s64, v112, 0
  v_readlane_b32 s65, v112, 1
  v_readlane_b32 s66, v112, 2
  v_readlane_b32 s67, v112, 3
  v_readlane_b32 s68, v112, 4
  v_readlane_b32 s69, v112, 5
  v_readlane_b32 s70, v112, 6
  v_readlane_b32 s71, v112, 7
  v_pk_add_f32 v[76:77], v[76:77], v[78:79]
  v_pk_add_f32 v[80:81], v[80:81], v[82:83]
  v_pk_add_f32 v[84:85], v[84:85], v[86:87]
  v_pk_add_f32 v[88:89], v[88:89], v[90:91]
  v_pk_add_f32 v[92:93], v[92:93], v[94:95]
  v_pk_add_f32 v[96:97], v[96:97], v[98:99]
  v_pk_add_f32 v[100:101], v[100:101], v[102:103]
  v_pk_add_f32 v[104:105], v[104:105], v[106:107]
  v_pk_mul_f32 v[116:117], v[76:77], s[64:65] op_sel:[0,0] op_sel_hi:[1,0]
  v_pk_mul_f32 v[118:119], v[80:81], s[64:65] op_sel:[0,1] op_sel_hi:[1,1]
  v_pk_fma_f32 v[116:117], v[84:85], s[66:67], v[116:117] op_sel:[0,0,0] op_sel_hi:[1,0,1]
  v_pk_fma_f32 v[118:119], v[88:89], s[66:67], v[118:119] op_sel:[0,1,0] op_sel_hi:[1,1,1]
  v_pk_fma_f32 v[116:117], v[92:93], s[68:69], v[116:117] op_sel:[0,0,0] op_sel_hi:[1,0,1]
  v_pk_fma_f32 v[118:119], v[96:97], s[68:69], v[118:119] op_sel:[0,1,0] op_sel_hi:[1,1,1]
  v_pk_fma_f32 v[116:117], v[100:101], s[70:71], v[116:117] op_sel:[0,0,0] op_sel_hi:[1,0,1]
  v_pk_fma_f32 v[118:119], v[104:105], s[70:71], v[118:119] op_sel:[0,1,0] op_sel_hi:[1,1,1]
  v_mul_f32 v111, v112, v109
  v_pk_add_f32 v[116:117], v[116:117], v[118:119]
  s_nop 0
  v_add_f32_dpp v111, v111, v111 quad_perm:[1,0,3,2] row_mask:0xf bank_mask:0xf
  v_cvt_pk_bf16_f32 v116, v116, v117
  v_min_u32 v116, 0xfffffffe, v116
  v_add_f32_dpp v111, v111, v111 quad_perm:[2,3,0,1] row_mask:0xf bank_mask:0xf
  v_min_u32 v110, 0xfffffffe, v110
  s_cmp_eq_u32 s59, 0
  s_cbranch_scc1 Ls_23
  buffer_store_dword v116, v3, s[16:19], s7 offen
  s_branch Lsd_24
Ls_23:
  buffer_store_dword v116, v3, s[16:19], s7 offen sc1
Lsd_24:
  v_add_f32_dpp v111, v111, v111 row_half_mirror row_mask:0xf bank_mask:0xf
  v_min_u32 v111, 0xfffffffe, v111
  s_mov_b32 exec_lo, 0x1
  s_mov_b32 exec_hi, 0x0
  s_cmp_eq_u32 s59, 0
  s_cbranch_scc1 Ls_25
  buffer_store_dwordx2 v[110:111], v4, s[16:19], s7 offen
  s_branch Lsd_26
Ls_25:
  buffer_store_dwordx2 v[110:111], v4, s[16:19], s7 offen sc1
Lsd_26:
  s_mov_b64 exec, -1
  s_setprio 0
L_role:
  s_cmp_eq_u32 s58, 0
  s_cbranch_scc1 L_WO
  s_cmp_eq_u32 s58, 3
  s_cbranch_scc1 L_next
  s_cmp_eq_u32 s6, 0
  s_cbranch_scc0 L_W1
  s_barrier
  s_mov_b32 s24, s44
  s_mov_b32 s25, s45
  s_mov_b32 s26, 0x21c000
  s_mov_b32 s27, 0x20000
  s_lshl_b32 s62, s3, 1
  s_add_u32 s61, s3, 2
  s_cmp_lt_u32 s3, 4
  s_cselect_b32 s72, s62, s61
  s_cselect_b32 s84, 8, 4
  s_mul_i32 s62, s72, 221184
  s_lshl_b32 s61, s75, 6
  s_add_u32 s82, s61, s62
  s_mov_b32 s83, 55296
  s_lshl_b32 s98, s72, 12
  s_add_u32 s98, s98, 51200
  v_lshrrev_b32 v76, 2, v0
  v_mul_u32_u24 v76, 3456, v76
  v_and_b32 v77, 3, v0
  v_lshl_add_u32 v17, v77, 4, v76
  s_mul_i32 s61, s3, 5
  s_mul_i32 s99, s75, 40960
  v_lshrrev_b32 v76, 3, v0
  v_mul_u32_u24 v78, 1280, v76
  v_and_b32 v77, 7, v0
  v_lshlrev_b32 v77, 4, v77
  v_bfe_u32 v76, v0, 4, 1
  v_lshlrev_b32 v76, 5, v76
  v_xor_b32 v77, v77, v76
  s_and_b32 s62, s61, 1
  s_lshl_b32 s62, s62, 6
  v_xor_b32 v77, s62, v77
  v_xor_b32 v76, 64, v77
  v_add_u32 v79, v78, v76
  v_add_u32 v78, v78, v77
  s_mov_b32 s20, s48
  s_mov_b32 s21, s49
  s_mov_b32 s22, 0x21c000
  s_mov_b32 s23, 0x20000
  s_cmp_lt_u32 s3, 4
  s_cbranch_scc0 L_m47
  s_mov_b32 s62, s98
  s_mov_b32 s61, s82
  s_mov_b32 m0, s62
  s_add_u32 s62, s62, 4096
  s_cmp_gt_u32 s84, 0
  s_cselect_b32 s63, s61, 0x40000000
  buffer_load_dwordx4 v17, s[24:27], s63 offen offset:0  lds
  s_add_u32 s61, s61, s83
  s_sub_u32 s61, s61, 1024
  s_cmp_gt_u32 s84, 1
  s_cselect_b32 s63, s61, 0x40000000
  buffer_load_dwordx4 v17, s[24:27], s63 offen offset:1024  lds
  s_add_u32 s61, s61, s83
  s_sub_u32 s61, s61, 1024
  s_cmp_gt_u32 s84, 2
  s_cselect_b32 s63, s61, 0x40000000
  buffer_load_dwordx4 v17, s[24:27], s63 offen offset:2048  lds
  s_add_u32 s61, s61, s83
  s_sub_u32 s61, s61, 1024
  s_cmp_gt_u32 s84, 3
  s_cselect_b32 s63, s61, 0x40000000
  buffer_load_dwordx4 v17, s[24:27], s63 offen offset:3072  lds
  s_add_u32 s61, s61, s83
  s_add_u32 s61, s61, 3072
  s_mov_b32 m0, s62
  s_cmp_gt_u32 s84, 4
  s_cselect_b32 s63, s61, 0x40000000
  buffer_load_dwordx4 v17, s[24:27], s63 offen offset:0  lds
  s_add_u32 s61, s61, s83
  s_sub_u32 s61, s61, 1024
  s_cmp_gt_u32 s84, 5
  s_cselect_b32 s63, s61, 0x40000000
  buffer_load_dwordx4 v17, s[24:27], s63 offen offset:1024  lds
  s_add_u32 s61, s61, s83
  s_sub_u32 s61, s61, 1024
  s_cmp_gt_u32 s84, 6
  s_cselect_b32 s63, s61, 0x40000000
  buffer_load_dwordx4 v17, s[24:27], s63 offen offset:2048  lds
  s_add_u32 s61, s61, s83
  s_sub_u32 s61, s61, 1024
  s_cmp_gt_u32 s84, 7
  s_cselect_b32 s63, s61, 0x40000000
  buffer_load_dwordx4 v17, s[24:27], s63 offen offset:3072  lds
  s_branch L_mdd
L_m47:
  s_cmp_lt_u32 s3, 6
  s_cbranch_scc1 L_m45
  s_mov_b32 s62, s98
  s_mov_b32 s61, s82
  s_mov_b32 m0, s62
  s_add_u32 s62, s62, 4096
  s_cmp_gt_u32 s84, 0
  s_cselect_b32 s63, s61, 0x40000000
  buffer_load_dwordx4 v17, s[24:27], s63 offen offset:0  lds
  s_add_u32 s61, s61, s83
  s_sub_u32 s61, s61, 1024
  s_cmp_gt_u32 s84, 1
  s_cselect_b32 s63, s61, 0x40000000
  buffer_load_dwordx4 v17, s[24:27], s63 offen offset:1024  lds
  s_add_u32 s61, s61, s83
  s_sub_u32 s61, s61, 1024
  s_cmp_gt_u32 s84, 2
  s_cselect_b32 s63, s61, 0x40000000
  buffer_load_dwordx4 v17, s[24:27], s63 offen offset:2048  lds
  s_add_u32 s61, s61, s83
  s_sub_u32 s61, s61, 1024
  s_cmp_gt_u32 s84, 3
  s_cselect_b32 s63, s61, 0x40000000
  buffer_load_dwordx4 v17, s[24:27], s63 offen offset:3072  lds
  s_add_u32 s61, s61, s83
  s_add_u32 s61, s61, 3072
  s_branch L_mdd
L_m45:
  s_cmp_eq_u32 s3, 5
  s_cbranch_scc0 L_mdd
  s_mov_b32 s20, s46
  s_mov_b32 s21, s47
  s_mov_b32 s22, 0xd80
  s_mov_b32 s23, 0x20000
  s_lshl_b32 s61, s75, 6
  v_and_b32 v80, 31, v0
  v_lshlrev_b32 v80, 1, v80
  v_mov_b32 v6, 0
  buffer_load_short_d16_hi v6, v80, s[20:23], s61 offen
L_mdd:
  s_mov_b32 s84, s98
  s_lshl_b32 s62, s72, 1
  s_and_b32 s63, s62, 15
  s_mul_i32 s63, s63, 512
  s_lshr_b32 s61, s62, 4
  s_lshl_b32 s61, s61, 14
  s_add_u32 s61, s61, s63
  v_and_b32 v81, 15, v0
  v_lshlrev_b32 v82, 6, v81
  v_lshrrev_b32 v83, 4, v0
  v_lshl_add_u32 v82, v83, 4, v82
  v_add_u32 v17, s61, v82
  s_lshl_b32 s61, s75, 7
  s_add_u32 s61, s61, 196608
  s_lshl_b32 s62, s3, 14
  s_add_u32 s62, s62, s61
  v_lshlrev_b32 v14, 2, v0
  v_add_u32 v14, s62, v14
  s_lshr_b32 s62, s3, 1
  s_add_u32 s62, s62, 6
  s_sub_u32 s83, s62, s3
  s_lshl_b32 s83, s83, 12
  s_lshl_b32 s62, s62, 14
  s_add_u32 s61, s61, s62
  s_and_b32 s98, s3, 1
  s_lshl_b32 s98, s98, 6
  s_add_u32 s61, s61, s98
  s_cmp_lt_u32 s3, 4
  s_cselect_b32 s61, 0x40000000, s61
  s_mov_b32 exec_lo, 0x0
  s_mov_b32 exec_hi, 0xffff
  v_lshl_add_u32 v14, v81, 2, s61
  s_mov_b32 exec_lo, 0x0
  s_mov_b32 exec_hi, 0xffff0000
  v_mov_b32 v14, 0x40000000
  s_mov_b64 exec, -1
  s_lshl_b32 s61, s3, 12
  s_add_u32 s61, s61, 92160
  v_lshrrev_b32 v82, 4, v0
  v_bfe_u32 v83, v0, 2, 2
  v_lshl_add_u32 v82, v82, 3, v83
  v_lshlrev_b32 v82, 7, v82
  v_and_b32 v83, 3, v0
  v_lshl_add_u32 v82, v83, 3, v82
  v_add_u32 v15, s61, v82
  v_bfe_u32 v82, v0, 3, 1
  v_bfe_u32 v83, v0, 4, 1
  v_lshl_add_u32 v83, v83, 1, v82
  v_lshl_add_u32 v15, v83, 5, v15
  v_mul_u32_u24 v82, 0xaaaa, v82
  v_or_b32 v25, 0x4444, v82
  v_bfe_u32 v82, v0, 4, 1
  v_and_b32 v83, 2, v0
  v_lshlrev_b32 v83, 3, v83
  v_lshl_add_u32 v13, v82, 5, v83
  s_mul_i32 s61, s3, 544
  v_lshrrev_b32 v83, 5, v0
  v_lshlrev_b32 v83, 7, v83
  v_lshl_add_u32 v83, v81, 3, v83
  v_lshl_add_u32 v83, v82, 2, v83
  v_add_u32 v7, s61, v83
  s_branch L_W1
L_WO:
  s_cmp_eq_u32 s6, 0
  s_cbranch_scc1 L_G1b
  s_barrier
  s_branch L_WO0
L_G1b:
  s_cmp_eq_u32 s6, 0
  s_cbranch_scc0 L_WO0
  s_lshl_b32 s61, s3, 13
  s_add_u32 s61, s61, 51200
  v_lshrrev_b32 v124, 4, v0
  v_bfe_u32 v125, v0, 2, 2
  v_lshl_add_u32 v124, v124, 3, v125
  v_lshlrev_b32 v124, 6, v124
  v_and_b32 v125, 3, v0
  v_lshl_add_u32 v124, v125, 3, v124
  v_add_u32 v123, s61, v124
  s_waitcnt vmcnt(0)
  ds_read_b64_tr_b16 v[44:45], v123 offset:0
  ds_read_b64_tr_b16 v[46:47], v123 offset:256
  ds_read_b64_tr_b16 v[48:49], v123 offset:32
  ds_read_b64_tr_b16 v[50:51], v123 offset:288
  ds_read_b64_tr_b16 v[52:53], v123 offset:2048
  ds_read_b64_tr_b16 v[54:55], v123 offset:2304
  ds_read_b64_tr_b16 v[56:57], v123 offset:2080
  ds_read_b64_tr_b16 v[58:59], v123 offset:2336
  s_waitcnt lgkmcnt(0)
L_WO0:
  s_cmp_eq_u32 s3, 5
  s_cbranch_scc0 L_WO1
  s_waitcnt vmcnt(0)
  v_lshlrev_b32 v72, 16, v72
L_WO1:
  v_mov_b32 v103, s80
  buffer_load_dwordx4 v[120:123], v12, s[16:19], s7 offen sc1
  buffer_load_dwordx2 v[124:125], v14, s[16:19], s7 offen sc1
Lp_27:
  s_add_u32 s60, s60, 1
  s_waitcnt vmcnt(0)
  v_max3_u32 v126, v120, v121, v122
  v_max3_u32 v126, v126, v123, v124
  v_max_u32 v126, v126, v125
  v_cmp_eq_u32 vcc, -1, v126
  s_cbranch_vccz Lpd_28
  v_max3_u32 v127, v120, v121, v122
  v_max_u32 v127, v127, v123
  v_cmp_eq_u32 s[86:87], -1, v127
  v_max_u32 v126, v124, v125
  v_cmp_eq_u32 s[88:89], -1, v126
  s_mov_b64 exec, s[86:87]
  buffer_load_dwordx4 v[120:123], v12, s[16:19], s7 offen sc1
  s_mov_b64 exec, s[88:89]
  buffer_load_dwordx2 v[124:125], v14, s[16:19], s7 offen sc1
  s_mov_b64 exec, -1
  s_cmp_lt_u32 s60, 400000
  s_cbranch_scc1 Lp_27
  s_waitcnt vmcnt(0)
Lpd_28:
  v_mfma_f32_16x16x32_bf16 v[84:87], v[120:123], v[44:47], 0
  v_max_f32_dpp v100, v124, v124 quad_perm:[1,0,3,2] row_mask:0xf bank_mask:0xf
  v_mfma_f32_16x16x32_bf16 v[88:91], v[120:123], v[52:55], 0
  v_max_f32_dpp v100, v100, v100 quad_perm:[2,3,0,1] row_mask:0xf bank_mask:0xf
  v_mfma_f32_16x16x32_bf16 v[92:95], v[120:123], v[48:51], 0
  v_max_f32_dpp v100, v100, v100 row_half_mirror row_mask:0xf bank_mask:0xf
  v_mfma_f32_16x16x32_bf16 v[96:99], v[120:123], v[56:59], 0
  v_sub_f32 v101, v124, v100
  v_mul_f32 v101, v101, v103
  v_exp_f32 v101, v101
  s_nop 0
  v_mul_f32 v102, v101, v125
  v_mov_b32_dpp v84, v88 quad_perm:[0,1,2,3] row_mask:0xc bank_mask:0xf
  v_mov_b32_dpp v85, v89 quad_perm:[0,1,2,3] row_mask:0xc bank_mask:0xf
  v_add_f32_dpp v102, v102, v102 quad_perm:[1,0,3,2] row_mask:0xf bank_mask:0xf
  v_mov_b32_dpp v86, v90 quad_perm:[0,1,2,3] row_mask:0xc bank_mask:0xf
  v_mov_b32_dpp v87, v91 quad_perm:[0,1,2,3] row_mask:0xc bank_mask:0xf
  v_add_f32_dpp v102, v102, v102 quad_perm:[2,3,0,1] row_mask:0xf bank_mask:0xf
  v_mov_b32_dpp v101, v101 row_ror:4 row_mask:0xf bank_mask:0xa
  v_mov_b32_dpp v92, v96 quad_perm:[0,1,2,3] row_mask:0xc bank_mask:0xf
  v_add_f32_dpp v102, v102, v102 row_half_mirror row_mask:0xf bank_mask:0xf
  v_mov_b32_dpp v93, v97 quad_perm:[0,1,2,3] row_mask:0xc bank_mask:0xf
  v_rcp_f32 v102, v102
  v_mov_b32_dpp v94, v98 quad_perm:[0,1,2,3] row_mask:0xc bank_mask:0xf
  v_mov_b32_dpp v95, v99 quad_perm:[0,1,2,3] row_mask:0xc bank_mask:0xf
  v_mul_f32_dpp v104, v101, v84 quad_perm:[0,0,0,0] row_mask:0xf bank_mask:0xf
  v_mul_f32_dpp v105, v101, v92 quad_perm:[0,0,0,0] row_mask:0xf bank_mask:0xf
  s_nop 0
  v_fmac_f32_dpp v104, v101, v85 quad_perm:[1,1,1,1] row_mask:0xf bank_mask:0xf
  v_fmac_f32_dpp v105, v101, v93 quad_perm:[1,1,1,1] row_mask:0xf bank_mask:0xf
  s_nop 0
  v_fmac_f32_dpp v104, v101, v86 quad_perm:[2,2,2,2] row_mask:0xf bank_mask:0xf
  v_fmac_f32_dpp v105, v101, v94 quad_perm:[2,2,2,2] row_mask:0xf bank_mask:0xf
  s_nop 0
  v_fmac_f32_dpp v104, v101, v87 quad_perm:[3,3,3,3] row_mask:0xf bank_mask:0xf
  v_fmac_f32_dpp v105, v101, v95 quad_perm:[3,3,3,3] row_mask:0xf bank_mask:0xf
  v_mul_f32 v104, v104, v102
  v_mul_f32 v105, v105, v102
  ds_write_b32 v7, v104 offset:2816
  ds_write_b32 v7, v105 offset:3072
  s_waitcnt lgkmcnt(0)
  s_barrier
  s_cmp_eq_u32 s3, 5
  s_cbranch_scc0 L_next
  s_setprio 3
  ds_read_b128 v[76:79], v1 offset:2816
  ds_read_b128 v[80:83], v1 offset:3360
  ds_read_b128 v[84:87], v1 offset:3904
  ds_read_b128 v[88:91], v1 offset:4448
  ds_read_b128 v[92:95], v1 offset:4992
  ds_read_b128 v[96:99], v1 offset:5536
  ds_read_b128 v[100:103], v1 offset:6080
  ds_read_b128 v[104:107], v1 offset:6624
  s_waitcnt lgkmcnt(0)
  v_add_f32 v106, v106, v72
  v_pk_add_f32 v[76:77], v[76:77], v[78:79]
  v_pk_add_f32 v[80:81], v[80:81], v[82:83]
  v_pk_add_f32 v[84:85], v[84:85], v[86:87]
  v_pk_add_f32 v[88:89], v[88:89], v[90:91]
  v_pk_add_f32 v[92:93], v[92:93], v[94:95]
  v_pk_add_f32 v[96:97], v[96:97], v[98:99]
  v_pk_add_f32 v[100:101], v[100:101], v[102:103]
  v_pk_add_f32 v[104:105], v[104:105], v[106:107]
  v_pk_add_f32 v[76:77], v[76:77], v[80:81]
  v_pk_add_f32 v[84:85], v[84:85], v[88:89]
  v_pk_add_f32 v[92:93], v[92:93], v[96:97]
  v_pk_add_f32 v[100:101], v[100:101], v[104:105]
  v_pk_add_f32 v[76:77], v[76:77], v[84:85]
  v_pk_add_f32 v[92:93], v[92:93], v[100:101]
  v_pk_add_f32 v[76:77], v[76:77], v[92:93]
  v_add_f32 v108, v76, v77
  s_nop 1
  v_mov_b32_dpp v115, v108 quad_perm:[1,0,3,2] row_mask:0xf bank_mask:0xf
  v_cvt_pk_bf16_f32 v114, v108, v115
  v_min_u32 v114, 0xfffffffe, v114
  v_mov_b32 v76, v114
  s_nop 0
  v_mov_b32_dpp v77, v114 quad_perm:[2,2,2,2] row_mask:0xf bank_mask:0xf
  v_mov_b32_dpp v78, v114 row_shl:4 row_mask:0xf bank_mask:0xf
  v_mov_b32_dpp v79, v114 row_shl:6 row_mask:0xf bank_mask:0xf
  s_mov_b32 exec_lo, 0x1010101
  s_mov_b32 exec_hi, 0x0
  buffer_store_dwordx4 v[76:79], v8, s[16:19], s7 offen sc1
  buffer_store_dwordx4 v[76:79], v8, s[16:19], s79 offen sc1
  s_mov_b64 exec, -1
  s_setprio 0
  s_branch L_next
L_W1:
  s_cmp_lt_u32 s3, 4
  s_cbranch_scc0 L_W4
  v_mov_b32 v104, 0x3f803f80
  v_mov_b32 v105, 0x3f803f80
  v_mov_b32 v106, 0x3f803f80
  v_mov_b32 v107, 0x3f803f80
  s_cmp_eq_u32 s6, 0
  s_cbranch_scc0 Lgw_29a
  v_bfe_u32 v122, v0, 3, 1
  v_lshlrev_b32 v122, 5, v122
  v_bfe_u32 v123, v0, 2, 1
  v_add_u32 v122, v122, v123
  v_lshrrev_b32 v123, 4, v0
  v_lshl_add_u32 v122, v123, 2, v122
  v_lshlrev_b32 v122, 6, v122
  v_and_b32 v123, 3, v0
  v_lshl_add_u32 v122, v123, 3, v122
  v_add_u32 v122, s84, v122
  s_lshl_b32 s61, s3, 7
  v_and_b32 v123, 15, v0
  v_lshlrev_b32 v123, 2, v123
  v_add_u32 v123, s61, v123
  s_waitcnt vmcnt(0)
  ds_read_b64_tr_b16 v[44:45], v122 offset:0
  ds_read_b64_tr_b16 v[46:47], v122 offset:128
  ds_read_b64_tr_b16 v[48:49], v122 offset:1024
  ds_read_b64_tr_b16 v[50:51], v122 offset:1152
  ds_read_b64_tr_b16 v[52:53], v122 offset:32
  ds_read_b64_tr_b16 v[54:55], v122 offset:160
  ds_read_b64_tr_b16 v[56:57], v122 offset:1056
  ds_read_b64_tr_b16 v[58:59], v122 offset:1184
  s_waitcnt lgkmcnt(0)
  ds_read_b64_tr_b16 v[60:61], v122 offset:4096
  ds_read_b64_tr_b16 v[62:63], v122 offset:4224
  ds_read_b64_tr_b16 v[64:65], v122 offset:5120
  ds_read_b64_tr_b16 v[66:67], v122 offset:5248
  ds_read_b64_tr_b16 v[68:69], v122 offset:4128
  ds_read_b64_tr_b16 v[70:71], v122 offset:4256
  ds_read_b64_tr_b16 v[72:73], v122 offset:5152
  ds_read_b64_tr_b16 v[74:75], v122 offset:5280
  s_waitcnt lgkmcnt(0)
  v_mfma_f32_16x16x32_bf16 v[76:79], v[104:107], v[44:47], 0
  v_mfma_f32_16x16x32_bf16 v[76:79], v[104:107], v[48:51], v[76:79]
  v_mfma_f32_16x16x32_bf16 v[76:79], v[104:107], v[60:63], v[76:79]
  v_mfma_f32_16x16x32_bf16 v[76:79], v[104:107], v[64:67], v[76:79]
  v_mfma_f32_16x16x32_bf16 v[80:83], v[104:107], v[52:55], 0
  v_mfma_f32_16x16x32_bf16 v[80:83], v[104:107], v[56:59], v[80:83]
  v_mfma_f32_16x16x32_bf16 v[80:83], v[104:107], v[68:71], v[80:83]
  v_mfma_f32_16x16x32_bf16 v[80:83], v[104:107], v[72:75], v[80:83]
  ds_write_b32 v123, v76 offset:7168
  s_nop 6
  ds_write_b32 v123, v80 offset:7232
  s_waitcnt lgkmcnt(0)
  s_barrier
Lgw_29a:
  ds_read_b64_tr_b16 v[28:29], v15
  ds_read_b64_tr_b16 v[30:31], v15 offset:512
  v_xor_b32 v127, 32, v15
  ds_read_b64_tr_b16 v[32:33], v127
  ds_read_b64_tr_b16 v[34:35], v127 offset:512
  v_xor_b32 v126, 64, v15
  ds_read_b64_tr_b16 v[36:37], v126
  ds_read_b64_tr_b16 v[38:39], v126 offset:512
  v_xor_b32 v127, 96, v15
  ds_read_b64_tr_b16 v[40:41], v127
  ds_read_b64_tr_b16 v[42:43], v127 offset:512
Lgw_29b:
  v_mov_b32 v76, 0
  v_mov_b32 v77, 0
  v_mov_b32 v78, 0
  v_mov_b32 v79, 0
  v_mov_b32 v80, 0
  v_mov_b32 v81, 0
  v_mov_b32 v82, 0
  v_mov_b32 v83, 0
  v_mov_b32 v84, 0
  v_mov_b32 v85, 0
  v_mov_b32 v86, 0
  v_mov_b32 v87, 0
  v_mov_b32 v92, 0
  v_mov_b32 v93, 0
  v_mov_b32 v94, 0
  v_mov_b32 v95, 0
  v_mov_b32 v96, 0
  v_mov_b32 v97, 0
  v_mov_b32 v98, 0
  v_mov_b32 v99, 0
  v_mov_b32 v120, 0
  v_mov_b32 v121, 0
  v_mov_b32 v122, 0
  v_mov_b32 v123, 0
  s_add_u32 s62, s7, 65536
  s_add_u32 s62, s62, s78
  s_mov_b32 s64, 0x00ff00ff
  s_mov_b32 s65, 0xff00ff00
  s_mov_b32 exec_lo, 0x3
  s_mov_b32 exec_hi, 0x0
Ll_30:
  buffer_load_dword v108, v17, s[16:19], s62 offen sc1
  s_add_u32 s60, s60, 1
  s_waitcnt vmcnt(0)
  v_cmp_ne_u32 vcc, -1, v108
  s_cbranch_vccnz Lld_31
  s_cmp_lt_u32 s60, 400000
  s_nop 1
  s_cbranch_scc1 Ll_30
Lld_31:
  s_mov_b64 exec, -1
  buffer_load_dwordx4 v[108:111], v17, s[16:19], s62 offen offset:0 sc1
  buffer_load_dwordx4 v[112:115], v17, s[16:19], s62 offen offset:1024 sc1
Lp_32:
  s_add_u32 s60, s60, 1
  s_waitcnt vmcnt(0)
  v_max_u32 v126, v108, v112
  v_cmp_eq_u32 vcc, -1, v126
  s_cbranch_vccz Lpd_33
  v_cmp_eq_u32 s[86:87], -1, v108
  v_cmp_eq_u32 s[88:89], -1, v112
  s_mov_b64 exec, s[86:87]
  buffer_load_dwordx4 v[108:111], v17, s[16:19], s62 offen offset:0 sc1
  s_mov_b64 exec, s[88:89]
  buffer_load_dwordx4 v[112:115], v17, s[16:19], s62 offen offset:1024 sc1
  s_mov_b64 exec, -1
  s_cmp_lt_u32 s60, 400000
  s_cbranch_scc1 Lp_32
  s_waitcnt vmcnt(0)
Lpd_33:
  v_mfma_f32_16x16x32_bf16 v[88:91], v[108:111], v[108:111], 0
  v_mfma_f32_16x16x32_bf16 v[88:91], v[112:115], v[112:115], v[88:91]
  v_smfmac_f32_16x16x64_bf16 v[84:87], v[104:107], v[108:115], v25
  v_smfmac_f32_16x16x64_bf16 v[76:79], v[108:111], v[44:51], v25
  v_smfmac_f32_16x16x64_bf16 v[80:83], v[108:111], v[52:59], v25
  v_smfmac_f32_16x16x64_bf16 v[76:79], v[112:115], v[60:67], v25
  v_pk_add_f32 v[88:89], v[88:89], v[90:91]
  v_add_f32 v88, v88, v89
  v_smfmac_f32_16x16x64_bf16 v[80:83], v[112:115], v[68:75], v25
  v_cndmask_b32 v85, 0, v88, s[64:65]
  v_add_f32_dpp v84, v84, v84 quad_perm:[1,0,3,2] row_mask:0xf bank_mask:0xf
  s_nop 0
  v_add_f32_dpp v85, v85, v85 quad_perm:[1,0,3,2] row_mask:0xf bank_mask:0xf
  v_add_f32_dpp v84, v84, v84 quad_perm:[2,3,0,1] row_mask:0xf bank_mask:0xf
  s_nop 0
  v_add_f32_dpp v85, v85, v85 quad_perm:[2,3,0,1] row_mask:0xf bank_mask:0xf
  v_pk_add_f32 v[76:77], v[76:77], v[78:79]
  v_add_f32_dpp v84, v84, v84 row_half_mirror row_mask:0xf bank_mask:0xf
  v_pk_add_f32 v[80:81], v[80:81], v[82:83]
  v_add_f32_dpp v85, v85, v85 row_half_mirror row_mask:0xf bank_mask:0xf
  v_add_f32 v76, v76, v77
  v_add_f32_dpp v84, v84, v84 row_mirror row_mask:0xf bank_mask:0xf
  v_add_f32 v80, v80, v81
  v_add_f32_dpp v85, v85, v85 row_mirror row_mask:0xf bank_mask:0xf
  s_nop 0
  v_permlane32_swap_b32 v76, v80
  v_add_f32_dpp v85, v85, v85 row_bcast:15 row_mask:0xa bank_mask:0xf
  v_add_f32 v76, v76, v80
  v_add_f32_dpp v84, v84, v84 row_bcast:31 row_mask:0xc bank_mask:0xf
  ds_write_b32 v7, v76 offset:0
  v_add_f32_dpp v85, v85, v85 row_bcast:31 row_mask:0xc bank_mask:0xf
  s_mov_b32 exec_lo, 0x0
  s_mov_b32 exec_hi, 0x80000000
  ds_write_b64 v7, v[84:85] offset:260
  s_mov_b64 exec, -1
  s_waitcnt lgkmcnt(0)
  s_barrier
  s_barrier
  s_mov_b32 exec_lo, 0x50005
  s_mov_b32 exec_hi, 0xa000a
  ds_read_b128 v[92:95], v13 offset:8784
  s_lshl_b64 exec, exec, 4
  ds_read_b128 v[96:99], v13 offset:8784
  s_mov_b64 exec, -1
  s_waitcnt lgkmcnt(1)
  v_smfmac_f32_16x16x64_bf16 v[120:123], v[92:95], v[28:35], v24
  s_waitcnt lgkmcnt(0)
  v_smfmac_f32_16x16x64_bf16 v[120:123], v[96:99], v[36:43], v24
  s_nop 7
  v_pk_add_f32 v[120:121], v[120:121], v[122:123]
  v_cvt_pk_bf16_f32 v120, v120, v121
  v_min_u32 v120, 0xfffffffe, v120
  buffer_store_dword v120, v14, s[16:19], s7 offen sc1
  buffer_store_dword v120, v14, s[16:19], s79 offen sc1
  s_branch L_next
L_W4:
  s_cmp_lt_u32 s3, 6
  s_cbranch_scc1 L_W45
  v_mov_b32 v104, 0x3f803f80
  v_mov_b32 v105, 0x3f803f80
  v_mov_b32 v106, 0x3f803f80
  v_mov_b32 v107, 0x3f803f80
  s_cmp_eq_u32 s6, 0
  s_cbranch_scc0 Lgw_34a
  v_bfe_u32 v122, v0, 3, 1
  v_lshlrev_b32 v122, 5, v122
  v_bfe_u32 v123, v0, 2, 1
  v_add_u32 v122, v122, v123
  v_lshrrev_b32 v123, 4, v0
  v_lshl_add_u32 v122, v123, 2, v122
  v_lshlrev_b32 v122, 6, v122
  v_and_b32 v123, 3, v0
  v_lshl_add_u32 v122, v123, 3, v122
  v_add_u32 v122, s84, v122
  s_lshl_b32 s61, s3, 7
  v_and_b32 v123, 15, v0
  v_lshlrev_b32 v123, 2, v123
  v_add_u32 v123, s61, v123
  s_waitcnt vmcnt(0)
  ds_read_b64_tr_b16 v[44:45], v122 offset:0
  ds_read_b64_tr_b16 v[46:47], v122 offset:128
  ds_read_b64_tr_b16 v[48:49], v122 offset:1024
  ds_read_b64_tr_b16 v[50:51], v122 offset:1152
  ds_read_b64_tr_b16 v[52:53], v122 offset:32
  ds_read_b64_tr_b16 v[54:55], v122 offset:160
  ds_read_b64_tr_b16 v[56:57], v122 offset:1056
  ds_read_b64_tr_b16 v[58:59], v122 offset:1184
  s_waitcnt lgkmcnt(0)
  v_mfma_f32_16x16x32_bf16 v[76:79], v[104:107], v[44:47], 0
  v_mfma_f32_16x16x32_bf16 v[76:79], v[104:107], v[48:51], v[76:79]
  v_mfma_f32_16x16x32_bf16 v[80:83], v[104:107], v[52:55], 0
  v_mfma_f32_16x16x32_bf16 v[80:83], v[104:107], v[56:59], v[80:83]
  ds_write_b32 v123, v76 offset:7168
  s_nop 6
  ds_write_b32 v123, v80 offset:7232
  s_waitcnt lgkmcnt(0)
  s_barrier
Lgw_34a:
  ds_read_b64_tr_b16 v[28:29], v15
  ds_read_b64_tr_b16 v[30:31], v15 offset:512
  v_xor_b32 v127, 32, v15
  ds_read_b64_tr_b16 v[32:33], v127
  ds_read_b64_tr_b16 v[34:35], v127 offset:512
  v_xor_b32 v126, 64, v15
  ds_read_b64_tr_b16 v[36:37], v126
  ds_read_b64_tr_b16 v[38:39], v126 offset:512
  v_xor_b32 v127, 96, v15
  ds_read_b64_tr_b16 v[40:41], v127
  ds_read_b64_tr_b16 v[42:43], v127 offset:512
  v_xor_b32 v126, s98, v15
  v_add_u32 v126, s83, v126
  ds_read_b64_tr_b16 v[68:69], v126
  ds_read_b64_tr_b16 v[70:71], v126 offset:512
  v_xor_b32 v127, 32, v126
  ds_read_b64_tr_b16 v[72:73], v127
  ds_read_b64_tr_b16 v[74:75], v127 offset:512
Lgw_34b:
  v_mov_b32 v76, 0
  v_mov_b32 v77, 0
  v_mov_b32 v78, 0
  v_mov_b32 v79, 0
  v_mov_b32 v80, 0
  v_mov_b32 v81, 0
  v_mov_b32 v82, 0
  v_mov_b32 v83, 0
  v_mov_b32 v84, 0
  v_mov_b32 v85, 0
  v_mov_b32 v86, 0
  v_mov_b32 v87, 0
  v_mov_b32 v92, 0
  v_mov_b32 v93, 0
  v_mov_b32 v94, 0
  v_mov_b32 v95, 0
  v_mov_b32 v96, 0
  v_mov_b32 v97, 0
  v_mov_b32 v98, 0
  v_mov_b32 v99, 0
  v_mov_b32 v100, 0
  v_mov_b32 v101, 0
  v_mov_b32 v102, 0
  v_mov_b32 v103, 0
  v_mov_b32 v120, 0
  v_mov_b32 v121, 0
  v_mov_b32 v122, 0
  v_mov_b32 v123, 0
  v_mov_b32 v112, 0
  v_mov_b32 v113, 0
  v_mov_b32 v114, 0
  v_mov_b32 v115, 0
  s_add_u32 s62, s7, 65536
  s_add_u32 s62, s62, s78
  s_mov_b32 s64, 0x00ff00ff
  s_mov_b32 s65, 0xff00ff00
  s_mov_b32 exec_lo, 0x3
  s_mov_b32 exec_hi, 0x0
Ll_35:
  buffer_load_dword v108, v17, s[16:19], s62 offen sc1
  s_add_u32 s60, s60, 1
  s_waitcnt vmcnt(0)
  v_cmp_ne_u32 vcc, -1, v108
  s_cbranch_vccnz Lld_36
  s_cmp_lt_u32 s60, 400000
  s_nop 1
  s_cbranch_scc1 Ll_35
Lld_36:
  s_mov_b64 exec, -1
  buffer_load_dwordx4 v[108:111], v17, s[16:19], s62 offen offset:0 sc1
Lp_37:
  s_add_u32 s60, s60, 1
  s_waitcnt vmcnt(0)
  v_cmp_eq_u32 vcc, -1, v108
  s_cbranch_vccz Lpd_38
  s_mov_b64 exec, vcc
  buffer_load_dwordx4 v[108:111], v17, s[16:19], s62 offen offset:0 sc1
  s_mov_b64 exec, -1
  s_cmp_lt_u32 s60, 400000
  s_cbranch_scc1 Lp_37
  s_waitcnt vmcnt(0)
Lpd_38:
  v_mfma_f32_16x16x32_bf16 v[88:91], v[108:111], v[108:111], 0
  v_smfmac_f32_16x16x64_bf16 v[84:87], v[104:107], v[108:115], v25
  v_smfmac_f32_16x16x64_bf16 v[76:79], v[108:111], v[44:51], v25
  v_smfmac_f32_16x16x64_bf16 v[80:83], v[108:111], v[52:59], v25
  v_pk_add_f32 v[88:89], v[88:89], v[90:91]
  v_add_f32 v88, v88, v89
  v_cndmask_b32 v85, 0, v88, s[64:65]
  v_add_f32_dpp v84, v84, v84 quad_perm:[1,0,3,2] row_mask:0xf bank_mask:0xf
  s_nop 0
  v_add_f32_dpp v85, v85, v85 quad_perm:[1,0,3,2] row_mask:0xf bank_mask:0xf
  v_add_f32_dpp v84, v84, v84 quad_perm:[2,3,0,1] row_mask:0xf bank_mask:0xf
  s_nop 0
  v_add_f32_dpp v85, v85, v85 quad_perm:[2,3,0,1] row_mask:0xf bank_mask:0xf
  v_pk_add_f32 v[76:77], v[76:77], v[78:79]
  v_add_f32_dpp v84, v84, v84 row_half_mirror row_mask:0xf bank_mask:0xf
  v_pk_add_f32 v[80:81], v[80:81], v[82:83]
  v_add_f32_dpp v85, v85, v85 row_half_mirror row_mask:0xf bank_mask:0xf
  v_add_f32 v76, v76, v77
  v_add_f32_dpp v84, v84, v84 row_mirror row_mask:0xf bank_mask:0xf
  v_add_f32 v80, v80, v81
  v_add_f32_dpp v85, v85, v85 row_mirror row_mask:0xf bank_mask:0xf
  s_nop 0
  v_permlane32_swap_b32 v76, v80
  v_add_f32_dpp v85, v85, v85 row_bcast:15 row_mask:0xa bank_mask:0xf
  v_add_f32 v76, v76, v80
  v_add_f32_dpp v84, v84, v84 row_bcast:31 row_mask:0xc bank_mask:0xf
  ds_write_b32 v7, v76 offset:0
  v_add_f32_dpp v85, v85, v85 row_bcast:31 row_mask:0xc bank_mask:0xf
  s_mov_b32 exec_lo, 0x0
  s_mov_b32 exec_hi, 0x80000000
  ds_write_b64 v7, v[84:85] offset:260
  s_mov_b64 exec, -1
  s_waitcnt lgkmcnt(0)
  s_barrier
  s_barrier
  s_mov_b32 exec_lo, 0x50005
  s_mov_b32 exec_hi, 0xa000a
  ds_read_b128 v[92:95], v13 offset:8784
  s_lshl_b64 exec, exec, 4
  ds_read_b128 v[96:99], v13 offset:8784
  s_lshl_b64 exec, exec, 4
  ds_read_b128 v[100:103], v13 offset:8784
  s_mov_b64 exec, -1
  s_waitcnt lgkmcnt(2)
  v_smfmac_f32_16x16x64_bf16 v[120:123], v[92:95], v[28:35], v24
  s_waitcnt lgkmcnt(1)
  v_smfmac_f32_16x16x64_bf16 v[120:123], v[96:99], v[36:43], v24
  s_waitcnt lgkmcnt(0)
  v_smfmac_f32_16x16x64_bf16 v[120:123], v[100:103], v[68:75], v24
  s_nop 7
  v_pk_add_f32 v[120:121], v[120:121], v[122:123]
  v_cvt_pk_bf16_f32 v120, v120, v121
  v_min_u32 v120, 0xfffffffe, v120
  buffer_store_dword v120, v14, s[16:19], s7 offen sc1
  buffer_store_dword v120, v14, s[16:19], s79 offen sc1
  s_branch L_next
L_W45:
  v_mov_b32 v92, 0
  v_mov_b32 v93, 0
  v_mov_b32 v94, 0
  v_mov_b32 v95, 0
  v_mov_b32 v96, 0
  v_mov_b32 v97, 0
  v_mov_b32 v98, 0
  v_mov_b32 v99, 0
  v_mov_b32 v100, 0
  v_mov_b32 v101, 0
  v_mov_b32 v102, 0
  v_mov_b32 v103, 0
  v_mov_b32 v120, 0
  v_mov_b32 v121, 0
  v_mov_b32 v122, 0
  v_mov_b32 v123, 0
  s_cmp_eq_u32 s3, 5
  s_cbranch_scc1 L_W5
  s_waitcnt vmcnt(0)
  s_cmp_eq_u32 s6, 0
  s_cbranch_scc0 Li_39
  s_barrier
Li_39:
  ds_read_b64_tr_b16 v[28:29], v15
  ds_read_b64_tr_b16 v[30:31], v15 offset:512
  v_xor_b32 v127, 32, v15
  ds_read_b64_tr_b16 v[32:33], v127
  ds_read_b64_tr_b16 v[34:35], v127 offset:512
  v_xor_b32 v126, 64, v15
  ds_read_b64_tr_b16 v[36:37], v126
  ds_read_b64_tr_b16 v[38:39], v126 offset:512
  v_xor_b32 v127, 96, v15
  ds_read_b64_tr_b16 v[40:41], v127
  ds_read_b64_tr_b16 v[42:43], v127 offset:512
  v_xor_b32 v126, s98, v15
  v_add_u32 v126, s83, v126
  ds_read_b64_tr_b16 v[68:69], v126
  ds_read_b64_tr_b16 v[70:71], v126 offset:512
  v_xor_b32 v127, 32, v126
  ds_read_b64_tr_b16 v[72:73], v127
  ds_read_b64_tr_b16 v[74:75], v127 offset:512
  s_mul_i32 s61, s75, 205
  s_lshr_b32 s61, s61, 11
  s_mul_i32 s62, s61, 10
  s_sub_u32 s62, s75, s62
  s_lshl_b32 s62, s62, 14
  s_lshl_b32 s61, s61, 7
  s_add_u32 s61, s61, s62
  s_add_u32 s61, s61, s7
  s_add_u32 s61, s61, 203776
  v_lshlrev_b32 v125, 13, v0
  s_mov_b32 exec_lo, 0x3
  s_mov_b32 exec_hi, 0x0
  s_waitcnt lgkmcnt(0)
  s_barrier
  buffer_store_dword v125, v125, s[16:19], s61 offen sc1
  s_mov_b64 exec, -1
  s_branch L_W1t
L_W5:
  v_mov_b32 v108, 0x3acccd10
  v_mov_b32 v109, 0x3acccd53
  v_mov_b32 v110, 0
  v_mov_b32 v111, 0x2edbe6ff
  v_mov_b32 v117, 0xc0135761
  v_mov_b32 v118, 0xbdd2d3e8
  v_lshlrev_b32 v124, 3, v0
  v_lshlrev_b32 v104, 2, v0
  v_mov_b32 v125, 0
  v_and_b32 v116, 17, v0
  v_and_b32 v115, 2, v0
  v_lshl_add_u32 v116, v115, 2, v116
  v_bfe_u32 v115, v0, 2, 2
  v_lshl_add_u32 v116, v115, 1, v116
  v_lshlrev_b32 v116, 1, v116
  s_waitcnt vmcnt(0)
  s_cmp_eq_u32 s6, 0
  s_cbranch_scc0 Li_40
  s_barrier
  ds_read_b32 v56, v104 offset:7168
  ds_read_b32 v57, v104 offset:7296
  ds_read_b32 v58, v104 offset:7424
  ds_read_b32 v59, v104 offset:7552
  ds_read_b32 v60, v104 offset:7936
  ds_read_b32 v61, v104 offset:8064
  s_waitcnt lgkmcnt(0)
  v_pk_add_f32 v[56:57], v[56:57], v[58:59]
  v_pk_add_f32 v[56:57], v[56:57], v[60:61]
  v_add_f32 v56, v56, v57
  v_mul_f32 v5, 0x3f7fffac, v56
Li_40:
  ds_read_b64_tr_b16 v[28:29], v15
  ds_read_b64_tr_b16 v[30:31], v15 offset:512
  v_xor_b32 v127, 32, v15
  ds_read_b64_tr_b16 v[32:33], v127
  ds_read_b64_tr_b16 v[34:35], v127 offset:512
  v_xor_b32 v126, 64, v15
  ds_read_b64_tr_b16 v[36:37], v126
  ds_read_b64_tr_b16 v[38:39], v126 offset:512
  v_xor_b32 v127, 96, v15
  ds_read_b64_tr_b16 v[40:41], v127
  ds_read_b64_tr_b16 v[42:43], v127 offset:512
  v_xor_b32 v126, s98, v15
  v_add_u32 v126, s83, v126
  ds_read_b64_tr_b16 v[68:69], v126
  ds_read_b64_tr_b16 v[70:71], v126 offset:512
  v_xor_b32 v127, 32, v126
  ds_read_b64_tr_b16 v[72:73], v127
  ds_read_b64_tr_b16 v[74:75], v127 offset:512
  s_waitcnt lgkmcnt(0)
L_W5a:
  s_setprio 3
  s_barrier
  ds_read_b64 v[44:45], v125 offset:512
  ds_read_b64 v[46:47], v125 offset:1056
  ds_read_b64 v[48:49], v125 offset:1600
  ds_read_b64 v[50:51], v125 offset:2144
  ds_read_b64 v[52:53], v125 offset:3776
  ds_read_b64 v[54:55], v125 offset:4320
  ds_read_b64 v[76:77], v124 offset:0
  ds_read_b64 v[78:79], v124 offset:544
  ds_read_b64 v[80:81], v124 offset:1088
  ds_read_b64 v[82:83], v124 offset:1632
  ds_read_b64 v[84:85], v124 offset:3264
  ds_read_b64 v[86:87], v124 offset:3808
  s_waitcnt lgkmcnt(6)
  v_pk_add_f32 v[44:45], v[44:45], v[46:47]
  v_pk_add_f32 v[48:49], v[48:49], v[50:51]
  v_pk_add_f32 v[52:53], v[52:53], v[54:55]
  v_pk_add_f32 v[44:45], v[44:45], v[48:49]
  v_pk_add_f32 v[44:45], v[44:45], v[52:53]
  v_pk_fma_f32 v[44:45], v[44:45], v[108:109], v[110:111]
  v_fma_f32 v113, -v44, v44, v45
  v_max_f32 v113, v113, v111
  v_rsq_f32 v113, v113
  s_waitcnt lgkmcnt(0)
  v_pk_add_f32 v[76:77], v[76:77], v[78:79]
  v_pk_add_f32 v[80:81], v[80:81], v[82:83]
  v_pk_add_f32 v[84:85], v[84:85], v[86:87]
  v_pk_add_f32 v[76:77], v[76:77], v[80:81]
  v_pk_add_f32 v[76:77], v[76:77], v[84:85]
  v_fma_f32 v77, -v44, v5, v77
  v_add_f32 v76, v76, v77
  v_fma_f32 v114, v76, v113, v6
  v_mul_f32 v115, v114, v114
  v_fma_f32 v115, v115, v118, v117
  v_mul_f32 v115, v115, v114
  v_exp_f32 v115, v115
  s_nop 0
  v_add_f32 v115, 1.0, v115
  v_rcp_f32 v115, v115
  s_mov_b32 exec_lo, 0xffffffff
  s_mov_b32 exec_hi, 0x0
  v_mul_f32 v114, v114, v115
  v_cvt_pk_bf16_f32 v114, v114, v114
  ds_write_b16 v116, v114 offset:8784
  s_mov_b64 exec, -1
  s_setprio 0
  s_waitcnt lgkmcnt(0)
L_W1t:
  s_barrier
  s_mov_b32 exec_lo, 0x50005
  s_mov_b32 exec_hi, 0xa000a
  ds_read_b128 v[92:95], v13 offset:8784
  s_lshl_b64 exec, exec, 4
  ds_read_b128 v[96:99], v13 offset:8784
  s_lshl_b64 exec, exec, 4
  ds_read_b128 v[100:103], v13 offset:8784
  s_mov_b64 exec, -1
  s_waitcnt lgkmcnt(2)
  v_smfmac_f32_16x16x64_bf16 v[120:123], v[92:95], v[28:35], v24
  s_waitcnt lgkmcnt(1)
  v_smfmac_f32_16x16x64_bf16 v[120:123], v[96:99], v[36:43], v24
  s_waitcnt lgkmcnt(0)
  v_smfmac_f32_16x16x64_bf16 v[120:123], v[100:103], v[68:75], v24
  s_nop 7
  v_pk_add_f32 v[120:121], v[120:121], v[122:123]
  v_cvt_pk_bf16_f32 v120, v120, v121
  v_min_u32 v120, 0xfffffffe, v120
  buffer_store_dword v120, v14, s[16:19], s7 offen sc1
  buffer_store_dword v120, v14, s[16:19], s79 offen sc1
  s_branch L_next
L_next:
  s_waitcnt vmcnt(0)
  s_add_u32 s6, s6, 1
  s_add_u32 s7, s7, 393216
  s_add_u32 s79, s79, 393216
  s_cmp_lt_u32 s6, 2
  s_cbranch_scc1 L_loop
  s_or_b32 s61, s58, s4
  s_cmp_eq_u32 s61, 0
  s_cbranch_scc0 L_fin
  s_cmp_eq_u32 s3, 6
  s_cbranch_scc1 L_loop
L_fin:
L_end:
  s_endpgm
.section .rodata,"a"
.p2align 6
.amdhsa_kernel interleave_layers__gqa_block_cached__mixer_channel_mlp__decode_kernel
  .amdhsa_next_free_vgpr 256
  .amdhsa_next_free_sgpr 102
  .amdhsa_accum_offset 256
  .amdhsa_group_segment_fixed_size 0
  .amdhsa_kernarg_size 104
  .amdhsa_user_sgpr_count 2
  .amdhsa_user_sgpr_kernarg_segment_ptr 1
  .amdhsa_system_sgpr_workgroup_id_x 1
.end_amdhsa_kernel
```
